```python
import torch

def _softmax(x, axis=-1):
    return torch.softmax(x, dim=axis)
def _gelu(x):
    return torch.nn.functional.gelu(x, approximate="tanh")
def _silu(x):
    return torch.nn.functional.silu(x)
def _sigmoid(x):
    return torch.sigmoid(x)
def _layernorm(x, axis=-1, eps=1e-5):
    m = x.mean(dim=axis, keepdim=True)
    v = x.var(dim=axis, keepdim=True, unbiased=False)
    return (x - m) / torch.sqrt(v + eps)
def _scatter_add(tgt, idx, src, axis=0):
    return tgt.clone().index_add_(axis, idx, src)
def _segment_sum(src, seg, n):
    out = torch.zeros((n,) + src.shape[1:], dtype=src.dtype)
    return out.index_add_(0, seg, src)
def _pad(x, pw):
    flat = tuple(v for pair in reversed(pw) for v in pair)
    return torch.nn.functional.pad(x, flat)

kernel_name = 'parallel_sum__sliding_block__dense_activation_squared_relu__prompt'

def setup_inputs():

    _w = (lambda a: (lambda t: t.to(torch.bfloat16) if t.is_floating_point() else t)(torch.as_tensor(a)))
    def _A_setup():
        B, S, D = 1, 2048, 512
        return {
            "x": _w((lambda *s: torch.randn(*s, dtype=torch.bfloat16) * 0.05)(B, S, D)),
            "wqkv": _w((lambda *s: torch.randn(*s, dtype=torch.bfloat16) * 0.1)(D, 3 * D)),
            "wo": _w((lambda *s: torch.randn(*s, dtype=torch.bfloat16) * 0.05)(D, D)),
        }
    _A_in = _A_setup()

    def _B_setup():
        B, S, D, F = 1, 2048, 512, 1792
        return {
            "x": _w((lambda *s: torch.randn(*s, dtype=torch.bfloat16) * 0.05)(B, S, D)),
            "w1": _w((lambda *s: torch.randn(*s, dtype=torch.bfloat16) * 0.05)(D, F)),
            "b1": _w((lambda *s: torch.randn(*s, dtype=torch.bfloat16) * 0.4)(F)),
            "w2": _w((lambda *s: torch.randn(*s, dtype=torch.bfloat16) * 0.05)(F, D)),
            "b2": _w((lambda *s: torch.randn(*s, dtype=torch.bfloat16) * 1.6)(D)),
        }
    _B_in = _B_setup()

    return {
        "A_x": _A_in["x"],
        "A_wqkv": _A_in["wqkv"],
        "A_wo": _A_in["wo"],
        "B_x": _B_in["x"],
        "B_w1": _B_in["w1"],
        "B_b1": _B_in["b1"],
        "B_w2": _B_in["w2"],
        "B_b2": _B_in["b2"],
    }

def reference(A_x, A_wqkv, A_wo, B_x, B_w1, B_b1, B_w2, B_b2):
    def _A_ref(x, wqkv, wo):
        B, S, D = x.shape
        H = 32; Dh = D // H; W = 256
        qkv = (lambda x, *d: x.permute(*d))((x @ wqkv).reshape(B, S, 3, H, Dh), 2, 0, 3, 1, 4)
        q, k, v = qkv[0], qkv[1], qkv[2]
        scores = torch.einsum("bhqd,bhkd->bhqk", q, k) * (Dh ** -0.5)
        idx = torch.arange(S)
        mask = (idx[:, None] - idx[None, :] >= 0) & (idx[:, None] - idx[None, :] < W)
        scores = torch.where(mask[None, None], scores, -1e9)
        p = _softmax(scores, axis=-1)
        o = torch.einsum("bhqk,bhkd->bhqd", p, v)
        return (lambda x, *d: x.permute(*d))(o, 0, 2, 1, 3).reshape(B, S, D) @ wo

    def _B_ref(x, w1, b1, w2, b2):
        h = torch.einsum("bsd,df->bsf", x, w1) + b1
        zero = torch.zeros_like(h)
        r = torch.where(h > zero, h, zero)
        h = r * r
        out = torch.einsum("bsf,fd->bsd", h, w2) + b2
        return out

    x = A_x
    xn = _layernorm(x, axis=-1)
    return x + _A_ref(xn, A_wqkv, A_wo) + _B_ref(xn, B_w1, B_b1, B_w2, B_b2)
```

```asm
; @launch grid=(256,1,1) block=(256,1,1) lds=163840
.amdgcn_target "amdgcn-amd-amdhsa--gfx950"
.text
.globl parallel_sum__sliding_block__dense_activation_squared_relu__prompt_kernel
.p2align 8
.type parallel_sum__sliding_block__dense_activation_squared_relu__prompt_kernel,@function
parallel_sum__sliding_block__dense_activation_squared_relu__prompt_kernel:
    s_cmp_ge_u32 s2, 256
    s_cbranch_scc1 L_end
    s_load_dwordx2 s[8:9], s[0:1], 0
    s_load_dwordx16 s[64:79], s[0:1], 0
    s_load_dwordx2 s[28:29], s[0:1], 64
    s_load_dwordx2 s[32:33], s[0:1], 80
    s_getpc_b64 s[4:5]
    v_lshlrev_b32 v1, 5, v0
    s_mov_b32 exec_lo, 0x11111111
    s_mov_b32 exec_hi, 0x11111111
    global_load_dword v7, v1, s[4:5] offset:128
    s_mov_b64 exec, -1
    v_lshrrev_b32 v1, 6, v0
    v_and_b32 v0, 63, v0
    v_readfirstlane_b32 s44, v1
    v_lshlrev_b32 v1, 4, v0
    s_bfe_u32 s45, s2, 0x10002
    s_lshr_b32 s55, s2, 5
    s_lshl3_add_u32 s45, s45, s55
    s_and_b32 s46, s2, 3
    s_bfe_u32 s56, s2, 0x20003
    s_lshl2_add_u32 s46, s46, s56
    s_lshl4_add_u32 s57, s45, s46
    s_lshl2_add_u32 s57, s57, s44
    s_mov_b32 s10, 2097152
    s_mov_b32 s11, 0x20000
    s_waitcnt lgkmcnt(0)
    s_lshl_b32 s63, s57, 11
    buffer_load_dwordx4 v[236:239], v1, s[8:11], s63 offen
    buffer_load_dwordx4 v[240:243], v1, s[8:11], s63 offen offset:1024
    s_lshl1_add_u32 s50, s56, s55
    s_and_b32 s51, s50, 5
    s_lshl_b32 s50, s51, 7
    s_lshl_b32 s52, s44, 12
    s_lshl2_add_u32 s54, s45, s44
    s_lshl_b32 s54, s54, 15
    v_lshrrev_b32 v244, 3, v0
    v_and_b32 v245, 7, v0
    v_lshrrev_b32 v246, 4, v0
    v_xor_b32 v245, v245, v246
    v_lshl_add_u32 v245, v245, 4, s54
    v_lshl_add_u32 v14, v244, 10, v245
    v_xor_b32 v245, 64, v14
    v_add_u32 v15, 7168, v245
    v_add_u32 v16, 14336, v14
    v_add_u32 v17, 21504, v245
    s_add_u32 m0, s52, 0
    s_nop 0
    buffer_load_dwordx4 v14, s[8:11], s50 offen offset:0 lds
    buffer_load_dwordx4 v15, s[8:11], s50 offen offset:1024 lds
    buffer_load_dwordx4 v16, s[8:11], s50 offen offset:2048 lds
    buffer_load_dwordx4 v17, s[8:11], s50 offen offset:3072 lds
    s_mov_b64 s[12:13], s[66:67]
    s_mov_b32 s14, 1572864
    s_mov_b32 s15, 0x20000
    s_mov_b64 s[16:17], s[72:73]
    s_mov_b32 s18, 1835008
    s_mov_b32 s19, 0x20000
    v_bfe_u32 v245, v0, 1, 2
    v_bfe_u32 v246, v0, 4, 1
    v_xor_b32 v245, v245, v246
    v_and_b32 v246, 1, v0
    v_lshlrev_b32 v246, 4, v246
    v_lshl_add_u32 v247, v245, 5, v246
    v_xor_b32 v248, 64, v247
    s_and_b32 s56, s46, 1
    s_lshr_b32 s53, s46, 1
    s_lshl_b32 s53, s53, 7
    s_mul_i32 s55, s44, 49152
    s_add_u32 s58, s53, s55
    s_lshl_b32 s54, s56, 10
    s_add_u32 s54, s54, s58
    s_add_u32 s54, s54, 1024
    s_mul_i32 s53, s44, 57344
    s_lshl_b32 s55, s46, 7
    s_add_u32 s53, s53, s55
    v_mul_u32_u24 v249, 3072, v244
    v_add3_u32 v18, v249, v247, s54
    s_add_u32 s54, s54, 23552
    v_add3_u32 v19, v249, v248, s54
    v_mul_u32_u24 v249, 3584, v244
    v_add3_u32 v20, v249, v247, s53
    s_add_u32 s53, s53, 27648
    v_add3_u32 v21, v249, v248, s53
    s_sub_u32 s16, s16, 2048
    s_subb_u32 s17, s17, 0
    s_mov_b32 s18, 1837056
    s_add_u32 m0, s52, 65536
    s_mul_i32 s54, s51, 196608
    buffer_load_dwordx4 v18, s[12:15], s54 offen offset:0 lds
    buffer_load_dwordx4 v19, s[12:15], s54 offen offset:1024 lds
    s_mul_i32 s54, s51, 229376
    buffer_load_dwordx4 v20, s[16:19], s54 offen offset:2048 lds
    buffer_load_dwordx4 v21, s[16:19], s54 offen offset:3072 lds
    s_mov_b32 s34, 15728640
    s_mov_b32 s35, 0x20000
    s_mov_b64 s[36:37], s[74:75]
    s_mov_b32 s38, 3584
    s_mov_b32 s39, 0x20000
    s_mov_b64 s[20:21], s[76:77]
    s_mov_b32 s22, 1835008
    s_mov_b32 s23, 0x20000
    s_mov_b64 s[24:25], s[68:69]
    s_mov_b32 s26, 524288
    s_mov_b32 s27, 0x20000
    s_mov_b64 s[40:41], s[78:79]
    s_mov_b32 s42, 1024
    s_mov_b32 s43, 0x20000
    s_mov_b32 s30, 2097152
    s_mov_b32 s31, 0x20000
    s_lshl_b32 s0, s57, 4
    s_add_u32 s0, s0, 13631488
    s_lshr_b32 s53, s57, 2
    s_lshl_b32 s53, s53, 7
    s_lshl2_add_u32 s53, s44, s53
    s_add_u32 s53, s53, 13647872
    v_mov_b32 v3, s53
    s_mov_b32 s57, 0x200000
    s_lshr_b32 s47, s44, 1
    s_and_b32 s48, s44, 1
    v_lshrrev_b32 v244, 2, v0
    v_bfe_u32 v245, v0, 1, 1
    v_lshrrev_b32 v246, 5, v0
    v_xor_b32 v245, v245, v246
    v_and_b32 v246, 1, v0
    v_lshlrev_b32 v246, 4, v246
    v_lshl_add_u32 v246, v245, 5, v246
    v_mul_u32_u24 v244, 3072, v244
    s_lshl_b32 s54, s56, 6
    s_add_u32 s54, s54, s58
    v_add3_u32 v22, v244, v246, s54
    s_lshl1_add_u32 s58, s45, s47
    s_lshl_b32 s58, s58, 1
    s_and_b32 s53, s46, 14
    s_add_u32 s53, s53, s48
    s_lshl_b32 s53, s53, 17
    s_lshl_b32 s54, s58, 10
    s_add_u32 s53, s53, s54
    s_lshl_b32 s54, s56, 21
    s_add_u32 s60, s53, s54
    s_lshl_b32 s54, s47, 16
    s_add_u32 s60, s60, s54
    s_lshr_b32 s53, s46, 2
    s_mul_i32 s53, s53, 3
    s_and_b32 s54, s46, 3
    s_cmp_eq_u32 s54, 3
    s_cselect_b32 s59, 1, 0
    s_add_u32 s53, s53, s54
    s_add_u32 s53, s53, 16
    s_mul_i32 s54, s58, 147456
    s_add_u32 s54, s54, 4194304
    s_lshl_b32 s55, s48, 12
    s_add_u32 s55, s55, s54
    s_lshl_b32 s61, s46, 13
    s_add_u32 s61, s61, s55
    s_lshl_b32 s62, s53, 13
    s_add_u32 s62, s62, s55
    s_add_u32 s63, s46, 56
    s_lshl_b32 s63, s63, 12
    s_add_u32 s63, s63, s54
    s_lshl_b32 s54, s48, 9
    s_add_u32 s63, s63, s54
    s_lshl_b32 s54, s46, 7
    s_lshl_b32 s53, s53, 7
    s_sub_u32 s1, s53, s54
    s_lshl_b32 s55, s48, 6
    s_add_u32 s54, s54, s55
    v_bfe_u32 v244, v0, 1, 1
    v_mul_lo_u32 v244, v244, s1
    v_and_b32 v245, 1, v0
    v_xor_b32 v245, s47, v245
    v_lshl_add_u32 v244, v245, 5, v244
    v_lshrrev_b32 v245, 4, v0
    v_lshl_add_u32 v244, v245, 3, v244
    v_add_u32 v48, s54, v244
    s_lshl_b32 s53, s59, 30
    s_add_u32 s101, s1, s53
    v_lshlrev_b32 v98, 7, v0
    s_lshl2_add_u32 s53, s2, s44
    s_mov_b32 s54, 13778944
    s_add_u32 s54, s54, s32
    s_addc_u32 s55, s33, 0
    s_sub_u32 s54, s54, 8064
    s_subb_u32 s55, s55, 0
    v_mov_b32 v97, s55
    v_add_co_u32 v96, vcc, s54, v98
    s_nop 1
    v_addc_co_u32 v97, vcc, 0, v97, vcc
    s_getpc_b64 s[4:5]
L_pc:
    s_lshr_b32 s54, s2, 3
    s_lshl2_add_u32 s54, s54, s44
    s_mul_i32 s54, s54, 384
    s_min_u32 s54, s54, L_end-L_pc-256
    s_add_u32 s54, s54, s4
    s_addc_u32 s55, s5, 0
    s_sub_u32 s54, s54, 4096
    s_subb_u32 s55, s55, 0
    s_mov_b32 exec_lo, 0x0
    s_mov_b32 exec_hi, 0x7
    v_mov_b32 v97, s55
    v_add_co_u32 v96, vcc, s54, v98
    s_nop 1
    v_addc_co_u32 v97, vcc, 0, v97, vcc
    s_bfe_u32 s54, s2, 0x30003
    s_lshl_b32 s54, s54, 7
    s_add_u32 s54, s54, s40
    s_addc_u32 s55, s41, 0
    s_sub_u32 s54, s54, 3840
    s_subb_u32 s55, s55, 0
    s_mov_b32 exec_lo, 0x40000000
    s_mov_b32 exec_hi, 0x0
    v_mov_b32 v97, s55
    v_add_co_u32 v96, vcc, s54, v98
    s_nop 1
    v_addc_co_u32 v97, vcc, 0, v97, vcc
    s_mov_b64 exec, -1
    v_and_b32 v244, 15, v0
    v_lshrrev_b32 v245, 4, v0
    v_lshrrev_b32 v246, 1, v244
    v_xor_b32 v246, v246, v245
    v_lshlrev_b32 v246, 4, v246
    v_lshl_add_u32 v246, v244, 7, v246
    s_lshl_b32 s53, s47, 13
    v_xor_b32 v23, s53, v246
    v_xor_b32 v24, 64, v23
    v_lshlrev_b32 v33, 3, v244
    s_lshl_b32 s53, s48, 12
    s_add_u32 s53, s53, 65536
    s_lshl_b32 s54, s47, 6
    s_add_u32 s55, s53, s54
    s_sub_u32 s53, s53, s54
    v_lshl_add_u32 v31, v244, 2, s55
    v_lshl_add_u32 v32, v245, 4, s55
    v_lshl_add_u32 v29, v245, 4, s53
    v_and_b32 v244, 1, v0
    s_mov_b32 s53, 0xaaaaaaaa
    v_mul_lo_u32 v244, v244, s53
    v_add_u32 v28, 0x44444444, v244
    v_bfe_u32 v244, v0, 2, 2
    v_bfe_u32 v245, v0, 4, 1
    v_lshl_add_u32 v246, v245, 3, v244
    v_lshrrev_b32 v247, 5, v0
    v_lshlrev_b32 v247, 12, v247
    v_and_b32 v248, 3, v0
    v_lshl_add_u32 v247, v248, 3, v247
    v_lshl_add_u32 v248, v246, 7, v247
    v_bfe_u32 v249, v0, 3, 2
    s_lshl1_add_u32 s53, s48, s47
    v_xor_b32 v249, s53, v249
    v_lshl_add_u32 v248, v249, 5, v248
    s_mov_b32 s53, 65536
    v_add_u32 v25, s53, v248
    v_xor_b32 v26, 32, v25
    v_lshl_add_u32 v248, v246, 6, v247
    v_xor_b32 v249, s48, v245
    v_lshl_add_u32 v248, v249, 5, v248
    v_add_u32 v27, s53, v248
    s_and_b32 s53, s2, 7
    s_lshr_b32 s54, s2, 6
    s_lshl2_add_u32 s53, s53, s54
    s_bfe_u32 s54, s2, 0x30003
    s_add_u32 s54, s54, 0
    s_and_b32 s54, s54, 7
    s_lshl_b32 s6, s54, 7
    s_mul_i32 s7, s53, 294912
    s_add_u32 s7, s7, 4194304
    s_lshl2_add_u32 s3, s53, s44
    s_lshl_b32 s3, s3, 14
    s_add_u32 s3, s3, s6
    v_lshrrev_b32 v244, 3, v0
    v_bfe_u32 v245, v0, 1, 2
    v_lshrrev_b32 v246, 4, v0
    v_xor_b32 v245, v245, v246
    v_and_b32 v246, 1, v0
    v_lshlrev_b32 v246, 4, v246
    v_lshl_add_u32 v246, v245, 5, v246
    v_lshl_add_u32 v246, v244, 10, v246
    v_add_u32 v12, s6, v246
    s_and_b32 s54, s53, 1
    s_lshl_b32 s54, s54, 14
    s_add_u32 s55, s54, 2048
    v_add_u32 v8, s55, v12
    v_add_u32 v9, 7168, v8
    s_sub_u32 s55, 16384, s54
    v_add_u32 v10, s55, v12
    v_add_u32 v11, 7168, v10
    s_sub_u32 s20, s20, 2048
    s_subb_u32 s21, s21, 0
    s_mov_b32 s22, 1837056
    v_and_b32 v245, 7, v0
    v_lshlrev_b32 v41, 4, v245
    v_lshl_add_u32 v40, v244, 10, v41
    s_lshr_b32 s54, s53, 1
    s_lshl2_add_u32 s54, s54, s44
    s_lshl_b32 s54, s54, 9
    s_and_b32 s53, s53, 1
    s_lshl3_add_u32 s54, s53, s54
    s_add_u32 s54, s54, 13680640
    v_bfe_u32 v246, v0, 1, 2
    v_lshlrev_b32 v246, 7, v246
    v_and_b32 v247, 1, v0
    v_lshl_add_u32 v246, v247, 2, v246
    v_add_u32 v6, s54, v246
    v_bfe_u32 v246, v0, 4, 1
    v_lshl_add_u32 v246, v246, 3, v244
    v_xor_b32 v246, v246, v245
    v_lshlrev_b32 v246, 4, v246
    v_lshl_add_u32 v246, v244, 8, v246
    s_lshl_b32 s55, s44, 14
    v_add_u32 v47, s55, v246
    v_and_b32 v244, 15, v0
    v_bfe_u32 v246, v0, 1, 1
    v_lshl_add_u32 v245, v246, 3, v245
    v_bfe_u32 v246, v0, 4, 1
    v_lshrrev_b32 v247, 5, v0
    v_lshl_add_u32 v248, v246, 3, v247
    v_xor_b32 v245, v245, v248
    v_lshlrev_b32 v245, 4, v245
    v_lshl_add_u32 v245, v244, 8, v245
    v_add_u32 v46, s52, v245
    v_lshlrev_b32 v246, 10, v246
    v_lshl_add_u32 v246, v247, 8, v246
    v_lshl_add_u32 v39, v244, 4, v246
    v_lshrrev_b32 v244, 2, v0
    v_and_b32 v245, 3, v0
    v_lshlrev_b32 v245, 3, v245
    v_lshl_add_u32 v245, v244, 7, v245
    v_bfe_u32 v244, v0, 3, 2
    v_lshl_add_u32 v245, v244, 5, v245
    v_add_u32 v42, s52, v245
    v_xor_b32 v43, 32, v42
    v_xor_b32 v44, 64, v42
    v_xor_b32 v45, 96, v42
    v_bfe_u32 v244, v0, 3, 2
    v_min_u32 v244, 2, v244
    v_min_u32 v244, s45, v244
    v_sub_u32 v244, s45, v244
    v_lshlrev_b32 v244, 4, v244
    v_bfe_u32 v245, v0, 2, 1
    s_and_b32 s53, s46, 14
    v_add3_u32 v244, v244, v245, s53
    v_lshlrev_b32 v244, 7, v244
    v_and_b32 v245, 3, v0
    v_lshl_add_u32 v244, v245, 2, v244
    v_add_u32 v5, 13647872, v244
    s_mov_b32 exec_lo, 0
    v_subrev_u32 v5, 32768, v6
    s_mov_b64 exec, -1
    s_mul_i32 s53, s44, 3
    s_lshl_b32 s99, s53, 12
    s_lshl2_add_u32 s53, s45, s53
    s_lshl_b32 s54, s46, 17
    s_sub_u32 s55, s53, 8
    s_cselect_b32 s55, 0x100000, s55
    s_lshl_b32 s55, s55, 10
    s_add_u32 s96, s55, s54
    s_sub_u32 s55, s53, 7
    s_cselect_b32 s55, 0x100000, s55
    s_lshl_b32 s55, s55, 10
    s_add_u32 s97, s55, s54
    s_sub_u32 s55, s53, 6
    s_cselect_b32 s55, 0x100000, s55
    s_lshl_b32 s55, s55, 10
    s_add_u32 s98, s55, s54
    s_lshl_b32 s53, s47, 13
    s_lshl_b32 s54, s48, 10
    s_add_u32 s53, s53, s54
    v_lshrrev_b32 v245, 5, v0
    v_lshlrev_b32 v246, 6, v245
    v_xor_b32 v35, v246, v1
    v_add_u32 v36, s53, v35
    v_bfe_u32 v244, v0, 1, 1
    v_xor_b32 v245, v245, v244
    v_lshlrev_b32 v244, 9, v244
    v_lshl_add_u32 v244, v245, 6, v244
    v_bfe_u32 v245, v0, 2, 2
    v_lshl_add_u32 v244, v245, 4, v244
    v_and_b32 v245, 1, v0
    v_lshl_add_u32 v244, v245, 3, v244
    s_add_u32 s53, s53, 2048
    v_add_u32 v37, s53, v244
    v_mov_b32 v38, 4096
    v_bfe_u32 v51, v0, 4, 1
    s_mov_b32 exec_lo, 0xffff0000
    s_mov_b32 exec_hi, 0xffff0000
    v_add_u32 v37, 115840, v33
    v_mov_b32 v38, 0
    s_mov_b64 exec, -1
    v_add_u32 v50, s7, v1
    s_lshr_b32 s47, s2, 6
    s_cmp_eq_u32 s6, 384
    s_cselect_b32 s47, s47, s47
    s_lshl2_add_u32 s1, s2, s44
    s_mul_i32 s48, s44, 6
    s_add_u32 s48, s48, 32
    v_mov_b32 v80, 0
    v_mov_b32 v81, 0
    v_mov_b32 v82, 0
    v_mov_b32 v83, 0
    v_mov_b32 v88, 0
    v_mov_b32 v89, 0
    v_mov_b32 v90, 0
    v_mov_b32 v91, 0
    v_mov_b32 v52, 0x3f803f80
    v_mov_b32 v53, 0x3f803f80
    v_mov_b32 v54, 0x3f803f80
    v_mov_b32 v55, 0x3f803f80
    s_mov_b32 s64, 0xffffffff
    s_mov_b32 s65, 0xfffffff0
    s_mov_b32 s66, 0xfffffffe
    s_mov_b32 s67, 0xffffffe0
    s_mov_b32 s68, 0xfffffffc
    s_mov_b32 s69, 0xffffffc0
    s_mov_b32 s70, 0xfffffff8
    s_mov_b32 s71, 0xffffff80
    s_mov_b32 s72, 0xffffff00
    s_mov_b32 s73, 0xfffff000
    s_mov_b32 s74, 0xfffffe00
    s_mov_b32 s75, 0xffffe000
    s_mov_b32 s76, 0xfffffc00
    s_mov_b32 s77, 0xffffc000
    s_mov_b32 s78, 0xfffff800
    s_mov_b32 s79, 0xffff8000
    s_mov_b32 s80, 0xffff0000
    s_mov_b32 s81, 0xfff00000
    s_mov_b32 s82, 0xfffe0000
    s_mov_b32 s83, 0xffe00000
    s_mov_b32 s84, 0xfffc0000
    s_mov_b32 s85, 0xffc00000
    s_mov_b32 s86, 0xfff80000
    s_mov_b32 s87, 0xff800000
    s_mov_b32 s88, 0xff000000
    s_mov_b32 s89, 0xf0000000
    s_mov_b32 s90, 0xfe000000
    s_mov_b32 s91, 0xe0000000
    s_mov_b32 s92, 0xfc000000
    s_mov_b32 s93, 0xc0000000
    s_mov_b32 s94, 0xf8000000
    s_mov_b32 s95, 0x80000000
    s_add_u32 m0, s52, 16384
    s_add_u32 s50, s50, 128
    s_and_b32 s50, s50, 1023
    buffer_load_dwordx4 v14, s[8:11], s50 offen offset:0 lds
    buffer_load_dwordx4 v15, s[8:11], s50 offen offset:1024 lds
    buffer_load_dwordx4 v16, s[8:11], s50 offen offset:2048 lds
    buffer_load_dwordx4 v17, s[8:11], s50 offen offset:3072 lds
    s_add_u32 m0, s52, 81920
    s_add_u32 s51, s51, 1
    s_and_b32 s51, s51, 7
    s_mul_i32 s54, s51, 196608
    buffer_load_dwordx4 v18, s[12:15], s54 offen offset:0 lds
    buffer_load_dwordx4 v19, s[12:15], s54 offen offset:1024 lds
    s_mul_i32 s54, s51, 229376
    buffer_load_dwordx4 v20, s[16:19], s54 offen offset:2048 lds
    buffer_load_dwordx4 v21, s[16:19], s54 offen offset:3072 lds
    s_waitcnt vmcnt(16)
    buffer_load_dwordx2 v[48:49], v48, s[36:39], 0 offen
    s_mov_b32 exec_lo, 0x40000000
    s_mov_b32 exec_hi, 0x80000007
    global_load_dword v2, v[96:97], off sc1
    s_mov_b64 exec, -1
    s_mov_b32 s39, s101
    s_lshl_b32 s36, s58, 8
    s_add_u32 s36, s36, 13631488
    v_lshlrev_b32 v56, 16, v236
    v_and_b32 v58, 0xffff0000, v236
    v_lshlrev_b32 v57, 16, v240
    v_and_b32 v59, 0xffff0000, v240
    v_lshlrev_b32 v60, 16, v237
    v_and_b32 v62, 0xffff0000, v237
    v_lshlrev_b32 v61, 16, v241
    v_and_b32 v63, 0xffff0000, v241
    v_lshlrev_b32 v64, 16, v238
    v_and_b32 v66, 0xffff0000, v238
    v_lshlrev_b32 v65, 16, v242
    v_and_b32 v67, 0xffff0000, v242
    v_lshlrev_b32 v68, 16, v239
    v_and_b32 v70, 0xffff0000, v239
    v_lshlrev_b32 v69, 16, v243
    v_and_b32 v71, 0xffff0000, v243
    v_pk_add_f32 v[72:73], v[56:57], v[58:59]
    v_pk_add_f32 v[72:73], v[72:73], v[60:61]
    v_pk_add_f32 v[72:73], v[72:73], v[62:63]
    v_pk_add_f32 v[72:73], v[72:73], v[64:65]
    v_pk_add_f32 v[72:73], v[72:73], v[66:67]
    v_pk_add_f32 v[72:73], v[72:73], v[68:69]
    v_pk_add_f32 v[72:73], v[72:73], v[70:71]
    s_nop 1
    v_add_f32 v72, v72, v72 row_ror:8 row_mask:0xf bank_mask:0xf
    v_add_f32 v73, v73, v73 row_ror:8 row_mask:0xf bank_mask:0xf
    s_nop 0
    v_add_f32 v72, v72, v72 row_ror:4 row_mask:0xf bank_mask:0xf
    v_add_f32 v73, v73, v73 row_ror:4 row_mask:0xf bank_mask:0xf
    s_nop 0
    v_add_f32 v72, v72, v72 row_ror:2 row_mask:0xf bank_mask:0xf
    v_add_f32 v73, v73, v73 row_ror:2 row_mask:0xf bank_mask:0xf
    s_nop 0
    v_add_f32 v72, v72, v72 row_ror:1 row_mask:0xf bank_mask:0xf
    v_add_f32 v73, v73, v73 row_ror:1 row_mask:0xf bank_mask:0xf
    v_mov_b32 v74, v72
    v_mov_b32 v75, v73
    s_nop 0
    v_permlane16_swap_b32 v72, v74
    v_permlane16_swap_b32 v73, v75
    v_add_f32 v72, v72, v74
    v_add_f32 v73, v73, v75
    v_mov_b32 v74, v72
    v_mov_b32 v75, v73
    s_nop 0
    v_permlane32_swap_b32 v72, v74
    v_permlane32_swap_b32 v73, v75
    v_add_f32 v72, v72, v74
    v_add_f32 v73, v73, v75
    v_mul_f32 v72, 0x3b000000, v72
    v_mul_f32 v73, 0x3b000000, v73
    v_pk_add_f32 v[56:57], v[56:57], v[72:73] neg_lo:[0,1] neg_hi:[0,1]
    v_pk_add_f32 v[58:59], v[58:59], v[72:73] neg_lo:[0,1] neg_hi:[0,1]
    v_pk_add_f32 v[60:61], v[60:61], v[72:73] neg_lo:[0,1] neg_hi:[0,1]
    v_pk_add_f32 v[62:63], v[62:63], v[72:73] neg_lo:[0,1] neg_hi:[0,1]
    v_pk_add_f32 v[64:65], v[64:65], v[72:73] neg_lo:[0,1] neg_hi:[0,1]
    v_pk_add_f32 v[66:67], v[66:67], v[72:73] neg_lo:[0,1] neg_hi:[0,1]
    v_pk_add_f32 v[68:69], v[68:69], v[72:73] neg_lo:[0,1] neg_hi:[0,1]
    v_pk_add_f32 v[70:71], v[70:71], v[72:73] neg_lo:[0,1] neg_hi:[0,1]
    v_pk_mul_f32 v[76:77], v[56:57], v[56:57]
    v_pk_fma_f32 v[76:77], v[58:59], v[58:59], v[76:77]
    v_pk_fma_f32 v[76:77], v[60:61], v[60:61], v[76:77]
    v_pk_fma_f32 v[76:77], v[62:63], v[62:63], v[76:77]
    v_pk_fma_f32 v[76:77], v[64:65], v[64:65], v[76:77]
    v_pk_fma_f32 v[76:77], v[66:67], v[66:67], v[76:77]
    v_pk_fma_f32 v[76:77], v[68:69], v[68:69], v[76:77]
    v_pk_fma_f32 v[76:77], v[70:71], v[70:71], v[76:77]
    s_nop 1
    v_add_f32 v76, v76, v76 row_ror:8 row_mask:0xf bank_mask:0xf
    v_add_f32 v77, v77, v77 row_ror:8 row_mask:0xf bank_mask:0xf
    s_nop 0
    v_add_f32 v76, v76, v76 row_ror:4 row_mask:0xf bank_mask:0xf
    v_add_f32 v77, v77, v77 row_ror:4 row_mask:0xf bank_mask:0xf
    s_nop 0
    v_add_f32 v76, v76, v76 row_ror:2 row_mask:0xf bank_mask:0xf
    v_add_f32 v77, v77, v77 row_ror:2 row_mask:0xf bank_mask:0xf
    s_nop 0
    v_add_f32 v76, v76, v76 row_ror:1 row_mask:0xf bank_mask:0xf
    v_add_f32 v77, v77, v77 row_ror:1 row_mask:0xf bank_mask:0xf
    v_mov_b32 v78, v76
    v_mov_b32 v79, v77
    s_nop 0
    v_permlane16_swap_b32 v76, v78
    v_permlane16_swap_b32 v77, v79
    v_add_f32 v76, v76, v78
    v_add_f32 v77, v77, v79
    v_mov_b32 v78, v76
    v_mov_b32 v79, v77
    s_nop 0
    v_permlane32_swap_b32 v76, v78
    v_permlane32_swap_b32 v77, v79
    v_add_f32 v76, v76, v78
    v_add_f32 v77, v77, v79
    v_mul_f32 v76, 0x3b000000, v76
    v_mul_f32 v77, 0x3b000000, v77
    v_cvt_pk_bf16_f32 v244, v76, v77
    v_lshlrev_b32 v76, 16, v244
    v_and_b32 v77, 0xffff0000, v244
    v_add_f32 v76, 0x3727c5ac, v76
    v_add_f32 v77, 0x3727c5ac, v77
    v_cvt_pk_bf16_f32 v244, v76, v77
    v_lshlrev_b32 v76, 16, v244
    v_and_b32 v77, 0xffff0000, v244
    v_sqrt_f32 v76, v76
    v_sqrt_f32 v77, v77
    v_cvt_pk_bf16_f32 v252, v72, v76
    v_cvt_pk_bf16_f32 v254, v73, v77
    s_waitcnt vmcnt(10)
    s_barrier
    ds_read_b64_tr_b16 v[108:109], v25 offset:0
    s_add_u32 m0, s52, 32768
    ds_read_b64_tr_b16 v[110:111], v25 offset:512
    s_add_u32 s50, s50, 128
    ds_read_b128 a[0:3], v23 offset:0
    ds_read_b64_tr_b16 v[112:113], v25 offset:8192
    s_and_b32 s50, s50, 1023
    ds_read_b64_tr_b16 v[114:115], v25 offset:8704
    buffer_load_dwordx4 v14, s[8:11], s50 offen offset:0 lds
    ds_read_b128 a[16:19], v24 offset:0
    ds_read_b128 a[4:7], v23 offset:2048
    buffer_load_dwordx4 v15, s[8:11], s50 offen offset:1024 lds
    ds_read_b128 a[20:23], v24 offset:2048
    buffer_load_dwordx4 v16, s[8:11], s50 offen offset:2048 lds
    ds_read_b128 a[8:11], v23 offset:4096
    ds_read_b128 a[24:27], v24 offset:4096
    buffer_load_dwordx4 v17, s[8:11], s50 offen offset:3072 lds
    ds_read_b128 a[12:15], v23 offset:6144
    s_add_u32 m0, s52, 98304
    ds_read_b128 a[28:31], v24 offset:6144
    ds_read_b64_tr_b16 v[116:117], v26 offset:0
    s_add_u32 s51, s51, 1
    ds_read_b64_tr_b16 v[118:119], v26 offset:512
    s_and_b32 s51, s51, 7
    ds_read_b64_tr_b16 v[120:121], v26 offset:8192
    ds_read_b64_tr_b16 v[122:123], v26 offset:8704
    s_mul_i32 s54, s51, 196608
    ds_read_b64_tr_b16 v[124:125], v25 offset:2048
    buffer_load_dwordx4 v18, s[12:15], s54 offen offset:0 lds
    ds_read_b64_tr_b16 v[126:127], v25 offset:2560
    ds_read_b64_tr_b16 v[128:129], v25 offset:10240
    buffer_load_dwordx4 v19, s[12:15], s54 offen offset:1024 lds
    ds_read_b64_tr_b16 v[130:131], v25 offset:10752
    s_mul_i32 s54, s51, 229376
    ds_read_b64_tr_b16 v[132:133], v26 offset:2048
    ds_read_b64_tr_b16 v[134:135], v26 offset:2560
    buffer_load_dwordx4 v20, s[16:19], s54 offen offset:2048 lds
    ds_read_b64_tr_b16 v[136:137], v26 offset:10240
    buffer_load_dwordx4 v21, s[16:19], s54 offen offset:3072 lds
    ds_read_b64_tr_b16 v[138:139], v26 offset:10752
    s_waitcnt lgkmcnt(8)
    v_mfma_f32_16x16x32_bf16 v[172:175], v[108:111], a[0:3], 0
    v_mfma_f32_16x16x32_bf16 v[172:175], v[112:115], a[16:19], v[172:175]
    v_mfma_f32_16x16x32_bf16 v[176:179], v[108:111], a[4:7], 0
    v_mfma_f32_16x16x32_bf16 v[176:179], v[112:115], a[20:23], v[176:179]
    s_waitcnt vmcnt(10) lgkmcnt(0)
    s_barrier
    v_mfma_f32_16x16x32_bf16 v[180:183], v[108:111], a[8:11], 0
    ds_read_b64_tr_b16 v[140:141], v25 offset:16384
    s_waitcnt vmcnt(8)
    v_readlane_b32 s49, v2, 63
    s_nop 0
    s_add_u32 s49, s49, 0x9e3779b1
    v_mov_b32 v2, s49
    v_mov_b32 v253, s49
    v_mfma_f32_16x16x32_bf16 v[180:183], v[112:115], a[24:27], v[180:183]
    ds_read_b64_tr_b16 v[142:143], v25 offset:16896
    v_mov_b32 v255, s49
    v_mfma_f32_16x16x32_bf16 v[184:187], v[108:111], a[12:15], 0
    ds_read_b128 a[32:35], v23 offset:16384
    s_mov_b64 exec, 1
    buffer_store_dwordx4 v[252:255], off, s[32:35], s0 sc1
    s_mov_b64 exec, -1
    v_mfma_f32_16x16x32_bf16 v[184:187], v[112:115], a[28:31], v[184:187]
    ds_read_b64_tr_b16 v[144:145], v25 offset:24576
    s_add_u32 m0, s52, 49152
    s_add_u32 s50, s50, 128
    v_mfma_f32_16x16x32_bf16 v[188:191], v[116:119], a[0:3], 0
    ds_read_b64_tr_b16 v[146:147], v25 offset:25088
    s_and_b32 s50, s50, 1023
    v_mfma_f32_16x16x32_bf16 v[188:191], v[120:123], a[16:19], v[188:191]
    ds_read_b128 a[48:51], v24 offset:16384
    buffer_load_dwordx4 v14, s[8:11], s50 offen offset:0 lds
    v_mfma_f32_16x16x32_bf16 v[192:195], v[116:119], a[4:7], 0
    ds_read_b128 a[36:39], v23 offset:18432
    v_mfma_f32_16x16x32_bf16 v[192:195], v[120:123], a[20:23], v[192:195]
    ds_read_b128 a[52:55], v24 offset:18432
    v_mfma_f32_16x16x32_bf16 v[196:199], v[116:119], a[8:11], 0
    ds_read_b128 a[40:43], v23 offset:20480
    v_mfma_f32_16x16x32_bf16 v[196:199], v[120:123], a[24:27], v[196:199]
    ds_read_b128 a[56:59], v24 offset:20480
    buffer_load_dwordx4 v15, s[8:11], s50 offen offset:1024 lds
    v_mfma_f32_16x16x32_bf16 v[200:203], v[116:119], a[12:15], 0
    ds_read_b128 a[44:47], v23 offset:22528
    v_mfma_f32_16x16x32_bf16 v[200:203], v[120:123], a[28:31], v[200:203]
    ds_read_b128 a[60:63], v24 offset:22528
    v_mfma_f32_16x16x32_bf16 v[204:207], v[124:127], a[0:3], 0
    buffer_load_dwordx4 v16, s[8:11], s50 offen offset:2048 lds
    v_mfma_f32_16x16x32_bf16 v[204:207], v[128:131], a[16:19], v[204:207]
    ds_read_b64_tr_b16 v[148:149], v26 offset:16384
    v_mfma_f32_16x16x32_bf16 v[208:211], v[124:127], a[4:7], 0
    ds_read_b64_tr_b16 v[150:151], v26 offset:16896
    v_mfma_f32_16x16x32_bf16 v[208:211], v[128:131], a[20:23], v[208:211]
    buffer_load_dwordx4 v17, s[8:11], s50 offen offset:3072 lds
    v_mfma_f32_16x16x32_bf16 v[212:215], v[124:127], a[8:11], 0
    ds_read_b64_tr_b16 v[152:153], v26 offset:24576
    s_add_u32 m0, s52, 114688
    s_add_u32 s51, s51, 1
    s_and_b32 s51, s51, 7
    v_mfma_f32_16x16x32_bf16 v[212:215], v[128:131], a[24:27], v[212:215]
    ds_read_b64_tr_b16 v[154:155], v26 offset:25088
    s_mul_i32 s54, s51, 196608
    v_mfma_f32_16x16x32_bf16 v[216:219], v[124:127], a[12:15], 0
    buffer_load_dwordx4 v18, s[12:15], s54 offen offset:0 lds
    v_mfma_f32_16x16x32_bf16 v[216:219], v[128:131], a[28:31], v[216:219]
    ds_read_b64_tr_b16 v[156:157], v25 offset:18432
    v_mfma_f32_16x16x32_bf16 v[220:223], v[132:135], a[0:3], 0
    ds_read_b64_tr_b16 v[158:159], v25 offset:18944
    v_mfma_f32_16x16x32_bf16 v[220:223], v[136:139], a[16:19], v[220:223]
    buffer_load_dwordx4 v19, s[12:15], s54 offen offset:1024 lds
    v_mfma_f32_16x16x32_bf16 v[224:227], v[132:135], a[4:7], 0
    ds_read_b64_tr_b16 v[160:161], v25 offset:26624
    v_mfma_f32_16x16x32_bf16 v[224:227], v[136:139], a[20:23], v[224:227]
    ds_read_b64_tr_b16 v[162:163], v25 offset:27136
    v_mfma_f32_16x16x32_bf16 v[228:231], v[132:135], a[8:11], 0
    ds_read_b64_tr_b16 v[164:165], v26 offset:18432
    s_mul_i32 s54, s51, 229376
    v_mfma_f32_16x16x32_bf16 v[228:231], v[136:139], a[24:27], v[228:231]
    buffer_load_dwordx4 v20, s[16:19], s54 offen offset:2048 lds
    v_mfma_f32_16x16x32_bf16 v[232:235], v[132:135], a[12:15], 0
    ds_read_b64_tr_b16 v[166:167], v26 offset:18944
    v_mfma_f32_16x16x32_bf16 v[232:235], v[136:139], a[28:31], v[232:235]
    ds_read_b64_tr_b16 v[168:169], v26 offset:26624
    v_smfmac_f32_16x16x64_bf16 v[80:83], v[52:55], v[108:115], v28
    buffer_load_dwordx4 v21, s[16:19], s54 offen offset:3072 lds
    v_smfmac_f32_16x16x64_bf16 v[88:91], v[52:55], v[124:131], v28
    ds_read_b64_tr_b16 v[170:171], v26 offset:27136
    s_waitcnt lgkmcnt(4)
    v_mfma_f32_16x16x32_bf16 v[172:175], v[140:143], a[32:35], v[172:175]
    v_mfma_f32_16x16x32_bf16 v[172:175], v[144:147], a[48:51], v[172:175]
    v_mfma_f32_16x16x32_bf16 v[176:179], v[140:143], a[36:39], v[176:179]
    v_mfma_f32_16x16x32_bf16 v[176:179], v[144:147], a[52:55], v[176:179]
    s_waitcnt vmcnt(9) lgkmcnt(0)
    s_barrier
    v_mfma_f32_16x16x32_bf16 v[180:183], v[140:143], a[40:43], v[180:183]
    ds_read_b64_tr_b16 v[108:109], v25 offset:32768
    s_add_u32 m0, s52, 0
    s_add_u32 s50, s50, 128
    v_mfma_f32_16x16x32_bf16 v[180:183], v[144:147], a[56:59], v[180:183]
    ds_read_b64_tr_b16 v[110:111], v25 offset:33280
    s_and_b32 s50, s50, 1023
    v_mfma_f32_16x16x32_bf16 v[184:187], v[140:143], a[44:47], v[184:187]
    ds_read_b128 a[64:67], v23 offset:32768
    buffer_load_dwordx4 v14, s[8:11], s50 offen offset:0 lds
    v_mfma_f32_16x16x32_bf16 v[184:187], v[144:147], a[60:63], v[184:187]
    ds_read_b64_tr_b16 v[112:113], v25 offset:40960
    v_mfma_f32_16x16x32_bf16 v[188:191], v[148:151], a[32:35], v[188:191]
    ds_read_b64_tr_b16 v[114:115], v25 offset:41472
    v_mfma_f32_16x16x32_bf16 v[188:191], v[152:155], a[48:51], v[188:191]
    ds_read_b128 a[80:83], v24 offset:32768
    v_mfma_f32_16x16x32_bf16 v[192:195], v[148:151], a[36:39], v[192:195]
    ds_read_b128 a[68:71], v23 offset:34816
    buffer_load_dwordx4 v15, s[8:11], s50 offen offset:1024 lds
    v_mfma_f32_16x16x32_bf16 v[192:195], v[152:155], a[52:55], v[192:195]
    ds_read_b128 a[84:87], v24 offset:34816
    v_mfma_f32_16x16x32_bf16 v[196:199], v[148:151], a[40:43], v[196:199]
    ds_read_b128 a[72:75], v23 offset:36864
    v_mfma_f32_16x16x32_bf16 v[196:199], v[152:155], a[56:59], v[196:199]
    ds_read_b128 a[88:91], v24 offset:36864
    v_mfma_f32_16x16x32_bf16 v[200:203], v[148:151], a[44:47], v[200:203]
    buffer_load_dwordx4 v16, s[8:11], s50 offen offset:2048 lds
    v_mfma_f32_16x16x32_bf16 v[200:203], v[152:155], a[60:63], v[200:203]
    ds_read_b128 a[76:79], v23 offset:38912
    v_mfma_f32_16x16x32_bf16 v[204:207], v[156:159], a[32:35], v[204:207]
    ds_read_b128 a[92:95], v24 offset:38912
    v_mfma_f32_16x16x32_bf16 v[204:207], v[160:163], a[48:51], v[204:207]
    buffer_load_dwordx4 v17, s[8:11], s50 offen offset:3072 lds
    v_mfma_f32_16x16x32_bf16 v[208:211], v[156:159], a[36:39], v[208:211]
    ds_read_b64_tr_b16 v[116:117], v26 offset:32768
    s_add_u32 m0, s52, 65536
    s_add_u32 s51, s51, 1
    v_mfma_f32_16x16x32_bf16 v[208:211], v[160:163], a[52:55], v[208:211]
    ds_read_b64_tr_b16 v[118:119], v26 offset:33280
    s_and_b32 s51, s51, 7
    v_mfma_f32_16x16x32_bf16 v[212:215], v[156:159], a[40:43], v[212:215]
    ds_read_b64_tr_b16 v[120:121], v26 offset:40960
    s_mul_i32 s54, s51, 196608
    v_mfma_f32_16x16x32_bf16 v[212:215], v[160:163], a[56:59], v[212:215]
    buffer_load_dwordx4 v18, s[12:15], s54 offen offset:0 lds
    v_mfma_f32_16x16x32_bf16 v[216:219], v[156:159], a[44:47], v[216:219]
    ds_read_b64_tr_b16 v[122:123], v26 offset:41472
    v_mfma_f32_16x16x32_bf16 v[216:219], v[160:163], a[60:63], v[216:219]
    ds_read_b64_tr_b16 v[124:125], v25 offset:34816
    v_mfma_f32_16x16x32_bf16 v[220:223], v[164:167], a[32:35], v[220:223]
    buffer_load_dwordx4 v19, s[12:15], s54 offen offset:1024 lds
    v_mfma_f32_16x16x32_bf16 v[220:223], v[168:171], a[48:51], v[220:223]
    ds_read_b64_tr_b16 v[126:127], v25 offset:35328
    v_mfma_f32_16x16x32_bf16 v[224:227], v[164:167], a[36:39], v[224:227]
    ds_read_b64_tr_b16 v[128:129], v25 offset:43008
    v_mfma_f32_16x16x32_bf16 v[224:227], v[168:171], a[52:55], v[224:227]
    ds_read_b64_tr_b16 v[130:131], v25 offset:43520
    s_mul_i32 s54, s51, 229376
    v_mfma_f32_16x16x32_bf16 v[228:231], v[164:167], a[40:43], v[228:231]
    buffer_load_dwordx4 v20, s[16:19], s54 offen offset:2048 lds
    v_mfma_f32_16x16x32_bf16 v[228:231], v[168:171], a[56:59], v[228:231]
    ds_read_b64_tr_b16 v[132:133], v26 offset:34816
    v_mfma_f32_16x16x32_bf16 v[232:235], v[164:167], a[44:47], v[232:235]
    ds_read_b64_tr_b16 v[134:135], v26 offset:35328
    v_mfma_f32_16x16x32_bf16 v[232:235], v[168:171], a[60:63], v[232:235]
    ds_read_b64_tr_b16 v[136:137], v26 offset:43008
    v_smfmac_f32_16x16x64_bf16 v[80:83], v[52:55], v[140:147], v28
    buffer_load_dwordx4 v21, s[16:19], s54 offen offset:3072 lds
    v_smfmac_f32_16x16x64_bf16 v[88:91], v[52:55], v[156:163], v28
    ds_read_b64_tr_b16 v[138:139], v26 offset:43520
    s_waitcnt lgkmcnt(4)
    v_mfma_f32_16x16x32_bf16 v[172:175], v[108:111], a[64:67], v[172:175]
    v_mfma_f32_16x16x32_bf16 v[172:175], v[112:115], a[80:83], v[172:175]
    v_mfma_f32_16x16x32_bf16 v[176:179], v[108:111], a[68:71], v[176:179]
    v_mfma_f32_16x16x32_bf16 v[176:179], v[112:115], a[84:87], v[176:179]
    s_waitcnt vmcnt(8) lgkmcnt(0)
    s_barrier
    v_mfma_f32_16x16x32_bf16 v[180:183], v[108:111], a[72:75], v[180:183]
    ds_read_b64_tr_b16 v[140:141], v25 offset:49152
    s_add_u32 m0, s52, 16384
    s_add_u32 s50, s50, 128
    v_mfma_f32_16x16x32_bf16 v[180:183], v[112:115], a[88:91], v[180:183]
    ds_read_b64_tr_b16 v[142:143], v25 offset:49664
    s_and_b32 s50, s50, 1023
    v_mfma_f32_16x16x32_bf16 v[184:187], v[108:111], a[76:79], v[184:187]
    ds_read_b128 a[96:99], v23 offset:49152
    buffer_load_dwordx4 v14, s[8:11], s50 offen offset:0 lds
    v_mfma_f32_16x16x32_bf16 v[184:187], v[112:115], a[92:95], v[184:187]
    ds_read_b64_tr_b16 v[144:145], v25 offset:57344
    v_mfma_f32_16x16x32_bf16 v[188:191], v[116:119], a[64:67], v[188:191]
    ds_read_b64_tr_b16 v[146:147], v25 offset:57856
    v_mfma_f32_16x16x32_bf16 v[188:191], v[120:123], a[80:83], v[188:191]
    ds_read_b128 a[112:115], v24 offset:49152
    v_mfma_f32_16x16x32_bf16 v[192:195], v[116:119], a[68:71], v[192:195]
    ds_read_b128 a[100:103], v23 offset:51200
    buffer_load_dwordx4 v15, s[8:11], s50 offen offset:1024 lds
    v_mfma_f32_16x16x32_bf16 v[192:195], v[120:123], a[84:87], v[192:195]
    ds_read_b128 a[116:119], v24 offset:51200
    v_mfma_f32_16x16x32_bf16 v[196:199], v[116:119], a[72:75], v[196:199]
    ds_read_b128 a[104:107], v23 offset:53248
    v_mfma_f32_16x16x32_bf16 v[196:199], v[120:123], a[88:91], v[196:199]
    ds_read_b128 a[120:123], v24 offset:53248
    v_mfma_f32_16x16x32_bf16 v[200:203], v[116:119], a[76:79], v[200:203]
    buffer_load_dwordx4 v16, s[8:11], s50 offen offset:2048 lds
    v_mfma_f32_16x16x32_bf16 v[200:203], v[120:123], a[92:95], v[200:203]
    ds_read_b128 a[108:111], v23 offset:55296
    v_mfma_f32_16x16x32_bf16 v[204:207], v[124:127], a[64:67], v[204:207]
    ds_read_b128 a[124:127], v24 offset:55296
    v_mfma_f32_16x16x32_bf16 v[204:207], v[128:131], a[80:83], v[204:207]
    buffer_load_dwordx4 v17, s[8:11], s50 offen offset:3072 lds
    v_mfma_f32_16x16x32_bf16 v[208:211], v[124:127], a[68:71], v[208:211]
    ds_read_b64_tr_b16 v[148:149], v26 offset:49152
    s_add_u32 m0, s52, 81920
    s_add_u32 s51, s51, 1
    v_mfma_f32_16x16x32_bf16 v[208:211], v[128:131], a[84:87], v[208:211]
    ds_read_b64_tr_b16 v[150:151], v26 offset:49664
    s_and_b32 s51, s51, 7
    v_mfma_f32_16x16x32_bf16 v[212:215], v[124:127], a[72:75], v[212:215]
    ds_read_b64_tr_b16 v[152:153], v26 offset:57344
    s_mul_i32 s54, s51, 196608
    v_mfma_f32_16x16x32_bf16 v[212:215], v[128:131], a[88:91], v[212:215]
    buffer_load_dwordx4 v18, s[12:15], s54 offen offset:0 lds
    v_mfma_f32_16x16x32_bf16 v[216:219], v[124:127], a[76:79], v[216:219]
    ds_read_b64_tr_b16 v[154:155], v26 offset:57856
    v_mfma_f32_16x16x32_bf16 v[216:219], v[128:131], a[92:95], v[216:219]
    ds_read_b64_tr_b16 v[156:157], v25 offset:51200
    v_mfma_f32_16x16x32_bf16 v[220:223], v[132:135], a[64:67], v[220:223]
    buffer_load_dwordx4 v19, s[12:15], s54 offen offset:1024 lds
    v_mfma_f32_16x16x32_bf16 v[220:223], v[136:139], a[80:83], v[220:223]
    ds_read_b64_tr_b16 v[158:159], v25 offset:51712
    v_mfma_f32_16x16x32_bf16 v[224:227], v[132:135], a[68:71], v[224:227]
    ds_read_b64_tr_b16 v[160:161], v25 offset:59392
    v_mfma_f32_16x16x32_bf16 v[224:227], v[136:139], a[84:87], v[224:227]
    ds_read_b64_tr_b16 v[162:163], v25 offset:59904
    s_mul_i32 s54, s51, 229376
    v_mfma_f32_16x16x32_bf16 v[228:231], v[132:135], a[72:75], v[228:231]
    buffer_load_dwordx4 v20, s[16:19], s54 offen offset:2048 lds
    v_mfma_f32_16x16x32_bf16 v[228:231], v[136:139], a[88:91], v[228:231]
    ds_read_b64_tr_b16 v[164:165], v26 offset:51200
    v_mfma_f32_16x16x32_bf16 v[232:235], v[132:135], a[76:79], v[232:235]
    ds_read_b64_tr_b16 v[166:167], v26 offset:51712
    v_mfma_f32_16x16x32_bf16 v[232:235], v[136:139], a[92:95], v[232:235]
    ds_read_b64_tr_b16 v[168:169], v26 offset:59392
    v_smfmac_f32_16x16x64_bf16 v[80:83], v[52:55], v[108:115], v28
    buffer_load_dwordx4 v21, s[16:19], s54 offen offset:3072 lds
    v_smfmac_f32_16x16x64_bf16 v[88:91], v[52:55], v[124:131], v28
    ds_read_b64_tr_b16 v[170:171], v26 offset:59904
    s_waitcnt lgkmcnt(4)
    v_mfma_f32_16x16x32_bf16 v[172:175], v[140:143], a[96:99], v[172:175]
    v_mfma_f32_16x16x32_bf16 v[172:175], v[144:147], a[112:115], v[172:175]
    v_mfma_f32_16x16x32_bf16 v[176:179], v[140:143], a[100:103], v[176:179]
    v_mfma_f32_16x16x32_bf16 v[176:179], v[144:147], a[116:119], v[176:179]
    s_waitcnt vmcnt(8) lgkmcnt(0)
    s_barrier
    v_mfma_f32_16x16x32_bf16 v[180:183], v[140:143], a[104:107], v[180:183]
    ds_read_b64_tr_b16 v[108:109], v25 offset:0
    s_add_u32 m0, s52, 32768
    s_add_u32 s50, s50, 128
    v_mfma_f32_16x16x32_bf16 v[180:183], v[144:147], a[120:123], v[180:183]
    ds_read_b64_tr_b16 v[110:111], v25 offset:512
    s_and_b32 s50, s50, 1023
    v_mfma_f32_16x16x32_bf16 v[184:187], v[140:143], a[108:111], v[184:187]
    ds_read_b128 a[128:131], v23 offset:0
    buffer_load_dwordx4 v14, s[8:11], s50 offen offset:0 lds
    v_mfma_f32_16x16x32_bf16 v[184:187], v[144:147], a[124:127], v[184:187]
    ds_read_b64_tr_b16 v[112:113], v25 offset:8192
    v_mfma_f32_16x16x32_bf16 v[188:191], v[148:151], a[96:99], v[188:191]
    ds_read_b64_tr_b16 v[114:115], v25 offset:8704
    v_mfma_f32_16x16x32_bf16 v[188:191], v[152:155], a[112:115], v[188:191]
    ds_read_b128 a[144:147], v24 offset:0
    v_mfma_f32_16x16x32_bf16 v[192:195], v[148:151], a[100:103], v[192:195]
    ds_read_b128 a[132:135], v23 offset:2048
    buffer_load_dwordx4 v15, s[8:11], s50 offen offset:1024 lds
    v_mfma_f32_16x16x32_bf16 v[192:195], v[152:155], a[116:119], v[192:195]
    ds_read_b128 a[148:151], v24 offset:2048
    v_mfma_f32_16x16x32_bf16 v[196:199], v[148:151], a[104:107], v[196:199]
    ds_read_b128 a[136:139], v23 offset:4096
    v_mfma_f32_16x16x32_bf16 v[196:199], v[152:155], a[120:123], v[196:199]
    ds_read_b128 a[152:155], v24 offset:4096
    v_mfma_f32_16x16x32_bf16 v[200:203], v[148:151], a[108:111], v[200:203]
    buffer_load_dwordx4 v16, s[8:11], s50 offen offset:2048 lds
    v_mfma_f32_16x16x32_bf16 v[200:203], v[152:155], a[124:127], v[200:203]
    ds_read_b128 a[140:143], v23 offset:6144
    v_mfma_f32_16x16x32_bf16 v[204:207], v[156:159], a[96:99], v[204:207]
    ds_read_b128 a[156:159], v24 offset:6144
    v_mfma_f32_16x16x32_bf16 v[204:207], v[160:163], a[112:115], v[204:207]
    buffer_load_dwordx4 v17, s[8:11], s50 offen offset:3072 lds
    v_mfma_f32_16x16x32_bf16 v[208:211], v[156:159], a[100:103], v[208:211]
    ds_read_b64_tr_b16 v[116:117], v26 offset:0
    s_add_u32 m0, s52, 98304
    s_add_u32 s51, s51, 1
    v_mfma_f32_16x16x32_bf16 v[208:211], v[160:163], a[116:119], v[208:211]
    ds_read_b64_tr_b16 v[118:119], v26 offset:512
    s_and_b32 s51, s51, 7
    v_mfma_f32_16x16x32_bf16 v[212:215], v[156:159], a[104:107], v[212:215]
    ds_read_b64_tr_b16 v[120:121], v26 offset:8192
    s_mul_i32 s54, s51, 196608
    v_mfma_f32_16x16x32_bf16 v[212:215], v[160:163], a[120:123], v[212:215]
    buffer_load_dwordx4 v18, s[12:15], s54 offen offset:0 lds
    v_mfma_f32_16x16x32_bf16 v[216:219], v[156:159], a[108:111], v[216:219]
    ds_read_b64_tr_b16 v[122:123], v26 offset:8704
    v_mfma_f32_16x16x32_bf16 v[216:219], v[160:163], a[124:127], v[216:219]
    ds_read_b64_tr_b16 v[124:125], v25 offset:2048
    v_mfma_f32_16x16x32_bf16 v[220:223], v[164:167], a[96:99], v[220:223]
    buffer_load_dwordx4 v19, s[12:15], s54 offen offset:1024 lds
    v_mfma_f32_16x16x32_bf16 v[220:223], v[168:171], a[112:115], v[220:223]
    ds_read_b64_tr_b16 v[126:127], v25 offset:2560
    v_mfma_f32_16x16x32_bf16 v[224:227], v[164:167], a[100:103], v[224:227]
    ds_read_b64_tr_b16 v[128:129], v25 offset:10240
    v_mfma_f32_16x16x32_bf16 v[224:227], v[168:171], a[116:119], v[224:227]
    ds_read_b64_tr_b16 v[130:131], v25 offset:10752
    s_mul_i32 s54, s51, 229376
    v_mfma_f32_16x16x32_bf16 v[228:231], v[164:167], a[104:107], v[228:231]
    buffer_load_dwordx4 v20, s[16:19], s54 offen offset:2048 lds
    v_mfma_f32_16x16x32_bf16 v[228:231], v[168:171], a[120:123], v[228:231]
    ds_read_b64_tr_b16 v[132:133], v26 offset:2048
    v_mfma_f32_16x16x32_bf16 v[232:235], v[164:167], a[108:111], v[232:235]
    ds_read_b64_tr_b16 v[134:135], v26 offset:2560
    v_mfma_f32_16x16x32_bf16 v[232:235], v[168:171], a[124:127], v[232:235]
    ds_read_b64_tr_b16 v[136:137], v26 offset:10240
    v_smfmac_f32_16x16x64_bf16 v[80:83], v[52:55], v[140:147], v28
    buffer_load_dwordx4 v21, s[16:19], s54 offen offset:3072 lds
    v_smfmac_f32_16x16x64_bf16 v[88:91], v[52:55], v[156:163], v28
    ds_read_b64_tr_b16 v[138:139], v26 offset:10752
    v_mov_b32_dpp v57, v48 quad_perm:[0,0,0,0] row_mask:0xf bank_mask:0xf
    v_mov_b32_dpp v59, v49 quad_perm:[0,0,0,0] row_mask:0xf bank_mask:0xf
    v_lshlrev_b32 v56, 16, v57
    v_and_b32 v57, 0xffff0000, v57
    v_lshlrev_b32 v58, 16, v59
    v_and_b32 v59, 0xffff0000, v59
    v_mov_b32_dpp v61, v48 quad_perm:[1,1,1,1] row_mask:0xf bank_mask:0xf
    v_mov_b32_dpp v63, v49 quad_perm:[1,1,1,1] row_mask:0xf bank_mask:0xf
    v_lshlrev_b32 v60, 16, v61
    v_and_b32 v61, 0xffff0000, v61
    v_lshlrev_b32 v62, 16, v63
    v_and_b32 v63, 0xffff0000, v63
    v_mov_b32_dpp v65, v48 quad_perm:[2,2,2,2] row_mask:0xf bank_mask:0xf
    v_mov_b32_dpp v67, v49 quad_perm:[2,2,2,2] row_mask:0xf bank_mask:0xf
    v_lshlrev_b32 v64, 16, v65
    v_and_b32 v65, 0xffff0000, v65
    v_lshlrev_b32 v66, 16, v67
    v_and_b32 v67, 0xffff0000, v67
    v_mov_b32_dpp v69, v48 quad_perm:[3,3,3,3] row_mask:0xf bank_mask:0xf
    v_mov_b32_dpp v71, v49 quad_perm:[3,3,3,3] row_mask:0xf bank_mask:0xf
    v_lshlrev_b32 v68, 16, v69
    v_and_b32 v69, 0xffff0000, v69
    v_lshlrev_b32 v70, 16, v71
    v_and_b32 v71, 0xffff0000, v71
    s_waitcnt lgkmcnt(0)
    v_mfma_f32_16x16x32_bf16 v[172:175], v[108:111], a[128:131], v[172:175]
    v_mfma_f32_16x16x32_bf16 v[172:175], v[112:115], a[144:147], v[172:175]
    v_mfma_f32_16x16x32_bf16 v[176:179], v[108:111], a[132:135], v[176:179]
    v_mfma_f32_16x16x32_bf16 v[176:179], v[112:115], a[148:151], v[176:179]
    s_waitcnt vmcnt(8)
    s_barrier
    v_mfma_f32_16x16x32_bf16 v[180:183], v[108:111], a[136:139], v[180:183]
    ds_read_b64_tr_b16 v[140:141], v25 offset:16384
    s_add_u32 m0, s52, 49152
    s_add_u32 s50, s50, 128
    v_mfma_f32_16x16x32_bf16 v[180:183], v[112:115], a[152:155], v[180:183]
    ds_read_b64_tr_b16 v[142:143], v25 offset:16896
    s_and_b32 s50, s50, 1023
    v_mfma_f32_16x16x32_bf16 v[184:187], v[108:111], a[140:143], v[184:187]
    ds_read_b128 a[160:163], v23 offset:16384
    buffer_load_dwordx4 v14, s[8:11], s50 offen offset:0 lds
    v_mfma_f32_16x16x32_bf16 v[184:187], v[112:115], a[156:159], v[184:187]
    ds_read_b64_tr_b16 v[144:145], v25 offset:24576
    v_mfma_f32_16x16x32_bf16 v[188:191], v[116:119], a[128:131], v[188:191]
    ds_read_b64_tr_b16 v[146:147], v25 offset:25088
    v_mfma_f32_16x16x32_bf16 v[188:191], v[120:123], a[144:147], v[188:191]
    ds_read_b128 a[176:179], v24 offset:16384
    buffer_load_dwordx4 v15, s[8:11], s50 offen offset:1024 lds
    v_mfma_f32_16x16x32_bf16 v[192:195], v[116:119], a[132:135], v[192:195]
    ds_read_b128 a[164:167], v23 offset:18432
    v_mfma_f32_16x16x32_bf16 v[192:195], v[120:123], a[148:151], v[192:195]
    ds_read_b128 a[180:183], v24 offset:18432
    v_mfma_f32_16x16x32_bf16 v[196:199], v[116:119], a[136:139], v[196:199]
    ds_read_b128 a[168:171], v23 offset:20480
    v_mfma_f32_16x16x32_bf16 v[196:199], v[120:123], a[152:155], v[196:199]
    ds_read_b128 a[184:187], v24 offset:20480
    buffer_load_dwordx4 v16, s[8:11], s50 offen offset:2048 lds
    v_mfma_f32_16x16x32_bf16 v[200:203], v[116:119], a[140:143], v[200:203]
    ds_read_b128 a[172:175], v23 offset:22528
    v_mfma_f32_16x16x32_bf16 v[200:203], v[120:123], a[156:159], v[200:203]
    ds_read_b128 a[188:191], v24 offset:22528
    v_mfma_f32_16x16x32_bf16 v[204:207], v[124:127], a[128:131], v[204:207]
    buffer_load_dwordx4 v17, s[8:11], s50 offen offset:3072 lds
    v_mfma_f32_16x16x32_bf16 v[204:207], v[128:131], a[144:147], v[204:207]
    ds_read_b64_tr_b16 v[148:149], v26 offset:16384
    s_add_u32 m0, s52, 114688
    s_add_u32 s51, s51, 1
    s_and_b32 s51, s51, 7
    v_mfma_f32_16x16x32_bf16 v[208:211], v[124:127], a[132:135], v[208:211]
    ds_read_b64_tr_b16 v[150:151], v26 offset:16896
    s_mul_i32 s54, s51, 196608
    v_mfma_f32_16x16x32_bf16 v[208:211], v[128:131], a[148:151], v[208:211]
    buffer_load_dwordx4 v18, s[12:15], s54 offen offset:0 lds
    v_mfma_f32_16x16x32_bf16 v[212:215], v[124:127], a[136:139], v[212:215]
    ds_read_b64_tr_b16 v[152:153], v26 offset:24576
    v_mfma_f32_16x16x32_bf16 v[212:215], v[128:131], a[152:155], v[212:215]
    ds_read_b64_tr_b16 v[154:155], v26 offset:25088
    v_mfma_f32_16x16x32_bf16 v[216:219], v[124:127], a[140:143], v[216:219]
    buffer_load_dwordx4 v19, s[12:15], s54 offen offset:1024 lds
    v_mfma_f32_16x16x32_bf16 v[216:219], v[128:131], a[156:159], v[216:219]
    ds_read_b64_tr_b16 v[156:157], v25 offset:18432
    v_mfma_f32_16x16x32_bf16 v[220:223], v[132:135], a[128:131], v[220:223]
    ds_read_b64_tr_b16 v[158:159], v25 offset:18944
    s_mul_i32 s54, s51, 229376
    v_mfma_f32_16x16x32_bf16 v[220:223], v[136:139], a[144:147], v[220:223]
    buffer_load_dwordx4 v20, s[16:19], s54 offen offset:2048 lds
    v_mfma_f32_16x16x32_bf16 v[224:227], v[132:135], a[132:135], v[224:227]
    ds_read_b64_tr_b16 v[160:161], v25 offset:26624
    v_mfma_f32_16x16x32_bf16 v[224:227], v[136:139], a[148:151], v[224:227]
    ds_read_b64_tr_b16 v[162:163], v25 offset:27136
    v_mfma_f32_16x16x32_bf16 v[228:231], v[132:135], a[136:139], v[228:231]
    ds_read_b64_tr_b16 v[164:165], v26 offset:18432
    v_mfma_f32_16x16x32_bf16 v[228:231], v[136:139], a[152:155], v[228:231]
    buffer_load_dwordx4 v21, s[16:19], s54 offen offset:3072 lds
    v_mfma_f32_16x16x32_bf16 v[232:235], v[132:135], a[140:143], v[232:235]
    ds_read_b64_tr_b16 v[166:167], v26 offset:18944
    v_mfma_f32_16x16x32_bf16 v[232:235], v[136:139], a[156:159], v[232:235]
    ds_read_b64_tr_b16 v[168:169], v26 offset:26624
    v_smfmac_f32_16x16x64_bf16 v[80:83], v[52:55], v[108:115], v28
    s_lshl2_add_u32 s53, s2, s44
    s_mul_i32 s55, s53, 1792
    s_mov_b64 exec, 0x3fff
    buffer_load_dword v96, v98, s[20:23], s55 offen offset:2048
    s_lshl_b32 s55, s53, 9
    s_mov_b64 exec, 0xf
    buffer_load_dword v97, v98, s[24:27], s55 offen
    s_mov_b64 exec, -1
    v_smfmac_f32_16x16x64_bf16 v[88:91], v[52:55], v[124:131], v28
    ds_read_b64_tr_b16 v[170:171], v26 offset:27136
    s_waitcnt lgkmcnt(2)
    v_mfma_f32_16x16x32_bf16 v[172:175], v[140:143], a[160:163], v[172:175]
    v_mfma_f32_16x16x32_bf16 v[172:175], v[144:147], a[176:179], v[172:175]
    v_mfma_f32_16x16x32_bf16 v[176:179], v[140:143], a[164:167], v[176:179]
    v_mfma_f32_16x16x32_bf16 v[176:179], v[144:147], a[180:183], v[176:179]
    s_waitcnt vmcnt(10) lgkmcnt(0)
    s_barrier
    v_mfma_f32_16x16x32_bf16 v[180:183], v[140:143], a[168:171], v[180:183]
    ds_read_b64_tr_b16 v[108:109], v25 offset:32768
    s_add_u32 m0, s52, 65536
    s_add_u32 s51, s51, 1
    s_and_b32 s51, s51, 7
    v_add_u32 v20, s39, v20
    v_mfma_f32_16x16x32_bf16 v[180:183], v[144:147], a[184:187], v[180:183]
    ds_read_b64_tr_b16 v[110:111], v25 offset:33280
    v_add_u32 v21, s39, v21
    v_mfma_f32_16x16x32_bf16 v[184:187], v[140:143], a[172:175], v[184:187]
    ds_read_b128 a[192:195], v23 offset:32768
    s_mul_i32 s54, s51, 196608
    v_mfma_f32_16x16x32_bf16 v[184:187], v[144:147], a[188:191], v[184:187]
    buffer_load_dwordx4 v22, s[12:15], s54 offen lds
    v_mfma_f32_16x16x32_bf16 v[188:191], v[148:151], a[160:163], v[188:191]
    ds_read_b64_tr_b16 v[112:113], v25 offset:40960
    v_mfma_f32_16x16x32_bf16 v[188:191], v[152:155], a[176:179], v[188:191]
    ds_read_b64_tr_b16 v[114:115], v25 offset:41472
    v_mfma_f32_16x16x32_bf16 v[192:195], v[148:151], a[164:167], v[192:195]
    ds_read_b128 a[208:211], v24 offset:32768
    v_mfma_f32_16x16x32_bf16 v[192:195], v[152:155], a[180:183], v[192:195]
    ds_read_b128 a[196:199], v23 offset:34816
    s_mul_i32 s54, s51, 229376
    v_mfma_f32_16x16x32_bf16 v[196:199], v[148:151], a[168:171], v[196:199]
    buffer_load_dwordx4 v20, s[16:19], s54 offen offset:2048 lds
    v_mfma_f32_16x16x32_bf16 v[196:199], v[152:155], a[184:187], v[196:199]
    ds_read_b128 a[212:215], v24 offset:34816
    v_mfma_f32_16x16x32_bf16 v[200:203], v[148:151], a[172:175], v[200:203]
    ds_read_b128 a[200:203], v23 offset:36864
    v_mfma_f32_16x16x32_bf16 v[200:203], v[152:155], a[188:191], v[200:203]
    ds_read_b128 a[216:219], v24 offset:36864
    v_mfma_f32_16x16x32_bf16 v[204:207], v[156:159], a[160:163], v[204:207]
    ds_read_b128 a[204:207], v23 offset:38912
    v_mfma_f32_16x16x32_bf16 v[204:207], v[160:163], a[176:179], v[204:207]
    buffer_load_dwordx4 v21, s[16:19], s54 offen offset:3072 lds
    v_mfma_f32_16x16x32_bf16 v[208:211], v[156:159], a[164:167], v[208:211]
    ds_read_b128 a[220:223], v24 offset:38912
    s_add_u32 m0, s52, 81920
    s_add_u32 s51, s51, 1
    v_mfma_f32_16x16x32_bf16 v[208:211], v[160:163], a[180:183], v[208:211]
    ds_read_b64_tr_b16 v[116:117], v26 offset:32768
    s_and_b32 s51, s51, 7
    v_mfma_f32_16x16x32_bf16 v[212:215], v[156:159], a[168:171], v[212:215]
    ds_read_b64_tr_b16 v[118:119], v26 offset:33280
    s_mul_i32 s54, s51, 196608
    v_mfma_f32_16x16x32_bf16 v[212:215], v[160:163], a[184:187], v[212:215]
    buffer_load_dwordx4 v22, s[12:15], s54 offen lds
    v_mfma_f32_16x16x32_bf16 v[216:219], v[156:159], a[172:175], v[216:219]
    ds_read_b64_tr_b16 v[120:121], v26 offset:40960
    v_mfma_f32_16x16x32_bf16 v[216:219], v[160:163], a[188:191], v[216:219]
    ds_read_b64_tr_b16 v[122:123], v26 offset:41472
    v_mfma_f32_16x16x32_bf16 v[220:223], v[164:167], a[160:163], v[220:223]
    ds_read_b64_tr_b16 v[124:125], v25 offset:34816
    v_mfma_f32_16x16x32_bf16 v[220:223], v[168:171], a[176:179], v[220:223]
    ds_read_b64_tr_b16 v[126:127], v25 offset:35328
    s_mul_i32 s54, s51, 229376
    v_mfma_f32_16x16x32_bf16 v[224:227], v[164:167], a[164:167], v[224:227]
    buffer_load_dwordx4 v20, s[16:19], s54 offen offset:2048 lds
    v_mfma_f32_16x16x32_bf16 v[224:227], v[168:171], a[180:183], v[224:227]
    ds_read_b64_tr_b16 v[128:129], v25 offset:43008
    v_mfma_f32_16x16x32_bf16 v[228:231], v[164:167], a[168:171], v[228:231]
    ds_read_b64_tr_b16 v[130:131], v25 offset:43520
    v_mfma_f32_16x16x32_bf16 v[228:231], v[168:171], a[184:187], v[228:231]
    ds_read_b64_tr_b16 v[132:133], v26 offset:34816
    v_mfma_f32_16x16x32_bf16 v[232:235], v[164:167], a[172:175], v[232:235]
    ds_read_b64_tr_b16 v[134:135], v26 offset:35328
    v_mfma_f32_16x16x32_bf16 v[232:235], v[168:171], a[188:191], v[232:235]
    buffer_load_dwordx4 v21, s[16:19], s54 offen offset:3072 lds
    v_smfmac_f32_16x16x64_bf16 v[80:83], v[52:55], v[140:147], v28
    ds_read_b64_tr_b16 v[136:137], v26 offset:43008
    v_smfmac_f32_16x16x64_bf16 v[88:91], v[52:55], v[156:163], v28
    ds_read_b64_tr_b16 v[138:139], v26 offset:43520
    s_waitcnt lgkmcnt(6)
    v_mfma_f32_16x16x32_bf16 v[172:175], v[108:111], a[192:195], v[172:175]
    v_mfma_f32_16x16x32_bf16 v[172:175], v[112:115], a[208:211], v[172:175]
    v_mfma_f32_16x16x32_bf16 v[176:179], v[108:111], a[196:199], v[176:179]
    v_mfma_f32_16x16x32_bf16 v[176:179], v[112:115], a[212:215], v[176:179]
    s_waitcnt vmcnt(8) lgkmcnt(0)
    s_barrier
    v_mfma_f32_16x16x32_bf16 v[180:183], v[108:111], a[200:203], v[180:183]
    ds_read_b64_tr_b16 v[140:141], v25 offset:49152
    s_add_u32 m0, s52, 98304
    s_add_u32 s51, s51, 1
    v_mfma_f32_16x16x32_bf16 v[180:183], v[112:115], a[216:219], v[180:183]
    ds_read_b64_tr_b16 v[142:143], v25 offset:49664
    s_and_b32 s51, s51, 7
    v_mfma_f32_16x16x32_bf16 v[184:187], v[108:111], a[204:207], v[184:187]
    ds_read_b128 a[224:227], v23 offset:49152
    s_mul_i32 s54, s51, 196608
    v_mfma_f32_16x16x32_bf16 v[184:187], v[112:115], a[220:223], v[184:187]
    ds_read_b64_tr_b16 v[144:145], v25 offset:57344
    buffer_load_dwordx4 v22, s[12:15], s54 offen lds
    v_mfma_f32_16x16x32_bf16 v[188:191], v[116:119], a[192:195], v[188:191]
    ds_read_b64_tr_b16 v[146:147], v25 offset:57856
    v_mfma_f32_16x16x32_bf16 v[188:191], v[120:123], a[208:211], v[188:191]
    ds_read_b128 a[240:243], v24 offset:49152
    v_mfma_f32_16x16x32_bf16 v[192:195], v[116:119], a[196:199], v[192:195]
    ds_read_b128 a[228:231], v23 offset:51200
    s_mul_i32 s54, s51, 229376
    v_mfma_f32_16x16x32_bf16 v[192:195], v[120:123], a[212:215], v[192:195]
    buffer_load_dwordx4 v20, s[16:19], s54 offen offset:2048 lds
    v_mfma_f32_16x16x32_bf16 v[196:199], v[116:119], a[200:203], v[196:199]
    ds_read_b128 a[244:247], v24 offset:51200
    v_mfma_f32_16x16x32_bf16 v[196:199], v[120:123], a[216:219], v[196:199]
    ds_read_b128 a[232:235], v23 offset:53248
    v_mfma_f32_16x16x32_bf16 v[200:203], v[116:119], a[204:207], v[200:203]
    ds_read_b128 a[248:251], v24 offset:53248
    v_mfma_f32_16x16x32_bf16 v[200:203], v[120:123], a[220:223], v[200:203]
    buffer_load_dwordx4 v21, s[16:19], s54 offen offset:3072 lds
    v_mfma_f32_16x16x32_bf16 v[204:207], v[124:127], a[192:195], v[204:207]
    ds_read_b128 a[236:239], v23 offset:55296
    s_add_u32 m0, s52, 131072
    v_mfma_f32_16x16x32_bf16 v[204:207], v[128:131], a[208:211], v[204:207]
    ds_read_b128 a[252:255], v24 offset:55296
    s_lshl2_add_u32 s100, s44, s47
    v_mfma_f32_16x16x32_bf16 v[208:211], v[124:127], a[196:199], v[208:211]
    ds_read_b64_tr_b16 v[148:149], v26 offset:49152
    s_lshl_b32 s100, s100, 16
    v_mfma_f32_16x16x32_bf16 v[208:211], v[128:131], a[212:215], v[208:211]
    buffer_load_dwordx4 v8, s[20:23], s100 offen offset:0 lds
    v_mfma_f32_16x16x32_bf16 v[212:215], v[124:127], a[200:203], v[212:215]
    ds_read_b64_tr_b16 v[150:151], v26 offset:49664
    v_mfma_f32_16x16x32_bf16 v[212:215], v[128:131], a[216:219], v[212:215]
    ds_read_b64_tr_b16 v[152:153], v26 offset:57344
    v_mfma_f32_16x16x32_bf16 v[216:219], v[124:127], a[204:207], v[216:219]
    ds_read_b64_tr_b16 v[154:155], v26 offset:57856
    v_mfma_f32_16x16x32_bf16 v[216:219], v[128:131], a[220:223], v[216:219]
    buffer_load_dwordx4 v9, s[20:23], s100 offen offset:1024 lds
    v_mfma_f32_16x16x32_bf16 v[220:223], v[132:135], a[192:195], v[220:223]
    ds_read_b64_tr_b16 v[156:157], v25 offset:51200
    v_mfma_f32_16x16x32_bf16 v[220:223], v[136:139], a[208:211], v[220:223]
    ds_read_b64_tr_b16 v[158:159], v25 offset:51712
    v_mfma_f32_16x16x32_bf16 v[224:227], v[132:135], a[196:199], v[224:227]
    ds_read_b64_tr_b16 v[160:161], v25 offset:59392
    v_mfma_f32_16x16x32_bf16 v[224:227], v[136:139], a[212:215], v[224:227]
    buffer_load_dwordx4 v10, s[20:23], s100 offen offset:2048 lds
    v_mfma_f32_16x16x32_bf16 v[228:231], v[132:135], a[200:203], v[228:231]
    ds_read_b64_tr_b16 v[162:163], v25 offset:59904
    v_mfma_f32_16x16x32_bf16 v[228:231], v[136:139], a[216:219], v[228:231]
    ds_read_b64_tr_b16 v[164:165], v26 offset:51200
    v_mfma_f32_16x16x32_bf16 v[232:235], v[132:135], a[204:207], v[232:235]
    ds_read_b64_tr_b16 v[166:167], v26 offset:51712
    v_mfma_f32_16x16x32_bf16 v[232:235], v[136:139], a[220:223], v[232:235]
    buffer_load_dwordx4 v11, s[20:23], s100 offen offset:3072 lds
    v_smfmac_f32_16x16x64_bf16 v[80:83], v[52:55], v[108:115], v28
    ds_read_b64_tr_b16 v[168:169], v26 offset:59392
    s_waitcnt vmcnt(14)
    v_mov_b32 v96, 0
    v_smfmac_f32_16x16x64_bf16 v[88:91], v[52:55], v[124:131], v28
    ds_read_b64_tr_b16 v[170:171], v26 offset:59904
    s_waitcnt vmcnt(13)
    v_mov_b32 v97, 0
    v_mov_b32 v98, 0
    v_mov_b32 v99, 0
    v_mov_b32 v104, 0
    v_mov_b32 v105, 0
    v_mov_b32 v106, 0
    v_mov_b32 v107, 0
    s_waitcnt lgkmcnt(2)
    v_smfmac_f32_16x16x64_bf16 v[80:83], v[52:55], v[140:147], v28
    v_smfmac_f32_16x16x64_bf16 v[88:91], v[52:55], v[156:163], v28
    v_mfma_f32_16x16x32_bf16 v[172:175], v[140:143], a[224:227], v[172:175]
    v_mfma_f32_16x16x32_bf16 v[172:175], v[144:147], a[240:243], v[172:175]
    v_mfma_f32_16x16x32_bf16 v[176:179], v[140:143], a[228:231], v[176:179]
    v_mfma_f32_16x16x32_bf16 v[176:179], v[144:147], a[244:247], v[176:179]
    v_mfma_f32_16x16x32_bf16 v[180:183], v[140:143], a[232:235], v[180:183]
    v_mfma_f32_16x16x32_bf16 v[180:183], v[144:147], a[248:251], v[180:183]
    v_mfma_f32_16x16x32_bf16 v[184:187], v[140:143], a[236:239], v[184:187]
    v_mfma_f32_16x16x32_bf16 v[184:187], v[144:147], a[252:255], v[184:187]
    v_mfma_f32_16x16x32_bf16 v[188:191], v[148:151], a[224:227], v[188:191]
    s_nop 1
    v_add_f32 v80, v80, v81
    ds_write_b32 v31, v80 offset:1024
    v_mfma_f32_16x16x32_bf16 v[188:191], v[152:155], a[240:243], v[188:191]
    v_add_f32 v88, v88, v89
    ds_write_b32 v31, v88 offset:1152
    v_mfma_f32_16x16x32_bf16 v[192:195], v[148:151], a[228:231], v[192:195]
    v_mfma_f32_16x16x32_bf16 v[192:195], v[152:155], a[244:247], v[192:195]
    v_mfma_f32_16x16x32_bf16 v[196:199], v[148:151], a[232:235], v[196:199]
    v_mfma_f32_16x16x32_bf16 v[196:199], v[152:155], a[248:251], v[196:199]
    s_waitcnt vmcnt(10) lgkmcnt(0)
    s_barrier
    v_mfma_f32_16x16x32_bf16 v[200:203], v[148:151], a[236:239], v[200:203]
    ds_read_b64_tr_b16 v[108:109], v25 offset:2048
    buffer_load_dwordx2 v[72:73], v33, s[32:35], s36 offen offset:0 sc1
    v_mfma_f32_16x16x32_bf16 v[200:203], v[152:155], a[252:255], v[200:203]
    ds_read_b64_tr_b16 v[110:111], v25 offset:2560
    v_mfma_f32_16x16x32_bf16 v[204:207], v[156:159], a[224:227], v[204:207]
    ds_read_b64_tr_b16 v[112:113], v25 offset:10240
    buffer_load_dwordx2 v[74:75], v33, s[32:35], s36 offen offset:128 sc1
    v_mfma_f32_16x16x32_bf16 v[204:207], v[160:163], a[240:243], v[204:207]
    ds_read_b64_tr_b16 v[114:115], v25 offset:10752
    v_mfma_f32_16x16x32_bf16 v[208:211], v[156:159], a[228:231], v[208:211]
    ds_read_b64_tr_b16 v[116:117], v26 offset:2048
    buffer_load_dwordx2 v[76:77], v33, s[32:35], s36 offen offset:256 sc1
    v_mfma_f32_16x16x32_bf16 v[208:211], v[160:163], a[244:247], v[208:211]
    ds_read_b64_tr_b16 v[118:119], v26 offset:2560
    buffer_load_dwordx2 v[78:79], v33, s[32:35], s36 offen offset:384 sc1
    v_mfma_f32_16x16x32_bf16 v[212:215], v[156:159], a[232:235], v[212:215]
    ds_read_b64_tr_b16 v[120:121], v26 offset:10240
    s_add_u32 m0, s52, 114688
    s_add_u32 s51, s51, 1
    s_and_b32 s51, s51, 7
    s_mul_i32 s54, s51, 196608
    v_mfma_f32_16x16x32_bf16 v[212:215], v[160:163], a[248:251], v[212:215]
    ds_read_b64_tr_b16 v[122:123], v26 offset:10752
    buffer_load_dwordx4 v22, s[12:15], s54 offen lds
    v_mfma_f32_16x16x32_bf16 v[216:219], v[156:159], a[236:239], v[216:219]
    ds_read_b64_tr_b16 v[124:125], v27 offset:0
    s_mul_i32 s54, s51, 229376
    v_mfma_f32_16x16x32_bf16 v[216:219], v[160:163], a[252:255], v[216:219]
    ds_read_b64_tr_b16 v[126:127], v27 offset:256
    buffer_load_dwordx4 v20, s[16:19], s54 offen offset:2048 lds
    v_mfma_f32_16x16x32_bf16 v[220:223], v[164:167], a[224:227], v[220:223]
    ds_read_b64_tr_b16 v[128:129], v27 offset:8192
    buffer_load_dwordx4 v21, s[16:19], s54 offen offset:3072 lds
    v_mfma_f32_16x16x32_bf16 v[220:223], v[168:171], a[240:243], v[220:223]
    ds_read_b64_tr_b16 v[130:131], v27 offset:8448
    s_add_u32 m0, s52, 147456
    s_xor_b32 s100, s100, 32768
    v_mfma_f32_16x16x32_bf16 v[224:227], v[164:167], a[228:231], v[224:227]
    ds_read_b128 v[80:83], v32 offset:1024
    buffer_load_dwordx4 v8, s[20:23], s100 offen offset:0 lds
    v_mfma_f32_16x16x32_bf16 v[224:227], v[168:171], a[244:247], v[224:227]
    ds_read_b128 v[84:87], v29 offset:1088
    buffer_load_dwordx4 v9, s[20:23], s100 offen offset:1024 lds
    v_mfma_f32_16x16x32_bf16 v[228:231], v[164:167], a[232:235], v[228:231]
    ds_read_b128 v[88:91], v32 offset:1152
    v_mfma_f32_16x16x32_bf16 v[228:231], v[168:171], a[248:251], v[228:231]
    buffer_load_dwordx4 v10, s[20:23], s100 offen offset:2048 lds
    v_mfma_f32_16x16x32_bf16 v[232:235], v[164:167], a[236:239], v[232:235]
    ds_read_b128 v[92:95], v29 offset:1216
    v_mfma_f32_16x16x32_bf16 v[232:235], v[168:171], a[252:255], v[232:235]
    buffer_load_dwordx4 v11, s[20:23], s100 offen offset:3072 lds
    s_waitcnt vmcnt(10)
    v_xor_b32 v34, s49, v73
    s_waitcnt vmcnt(9)
    v_bitop3_b32 v34, v34, s49, v75 bitop3:0xf6
    s_waitcnt vmcnt(8)
    v_bitop3_b32 v34, v34, s49, v77 bitop3:0xf6
    s_waitcnt vmcnt(7)
    v_bitop3_b32 v34, v34, s49, v79 bitop3:0xf6
    v_cmp_ne_u32 vcc, 0, v34
    s_nop 0
    s_cbranch_vccnz L_st_retry_1
L_st_ok_2:
    v_lshlrev_b32 v73, 16, v72
    v_and_b32 v72, 0xffff0000, v72
    v_lshlrev_b32 v75, 16, v74
    v_and_b32 v74, 0xffff0000, v74
    v_lshlrev_b32 v77, 16, v76
    v_and_b32 v76, 0xffff0000, v76
    v_lshlrev_b32 v79, 16, v78
    v_and_b32 v78, 0xffff0000, v78
    v_rcp_f32 v72, v72
    v_rcp_f32 v74, v74
    v_rcp_f32 v76, v76
    v_rcp_f32 v78, v78
    v_mul_f32 v73, -v73, v72
    v_mul_f32 v75, -v75, v74
    v_mul_f32 v77, -v77, v76
    v_mul_f32 v79, -v79, v78
    s_xor_b32 s53, s60, 65536
    s_waitcnt lgkmcnt(0)
    v_pk_mul_f32 v[156:157], v[80:81], v[72:73] op_sel:[0,1] op_sel_hi:[1,1]
    v_pk_mul_f32 v[158:159], v[82:83], v[72:73] op_sel:[0,1] op_sel_hi:[1,1]
    v_pk_fma_f32 v[172:173], v[172:173], v[72:73], v[156:157] op_sel_hi:[1,0,1]
    v_pk_fma_f32 v[174:175], v[174:175], v[72:73], v[158:159] op_sel_hi:[1,0,1]
    v_pk_mul_f32 v[160:161], v[80:81], v[74:75] op_sel:[0,1] op_sel_hi:[1,1]
    v_pk_mul_f32 v[162:163], v[82:83], v[74:75] op_sel:[0,1] op_sel_hi:[1,1]
    v_pk_fma_f32 v[176:177], v[176:177], v[74:75], v[160:161] op_sel_hi:[1,0,1]
    v_pk_fma_f32 v[178:179], v[178:179], v[74:75], v[162:163] op_sel_hi:[1,0,1]
    v_cvt_pk_bf16_f32 v140, v172, v173
    v_cvt_pk_bf16_f32 v141, v174, v175
    v_cvt_pk_bf16_f32 v142, v176, v177
    v_cvt_pk_bf16_f32 v143, v178, v179
    s_nop 0
    v_permlane16_swap_b32 v140, v142
    v_permlane16_swap_b32 v141, v143
    buffer_store_dwordx4 v[140:143], v35, s[32:35], s60 offen offset:0 sc1
    v_pk_mul_f32 v[156:157], v[80:81], v[76:77] op_sel:[0,1] op_sel_hi:[1,1]
    v_pk_mul_f32 v[158:159], v[82:83], v[76:77] op_sel:[0,1] op_sel_hi:[1,1]
    v_pk_fma_f32 v[180:181], v[180:181], v[76:77], v[156:157] op_sel_hi:[1,0,1]
    v_pk_fma_f32 v[182:183], v[182:183], v[76:77], v[158:159] op_sel_hi:[1,0,1]
    v_pk_mul_f32 v[160:161], v[80:81], v[78:79] op_sel:[0,1] op_sel_hi:[1,1]
    v_pk_mul_f32 v[162:163], v[82:83], v[78:79] op_sel:[0,1] op_sel_hi:[1,1]
    v_pk_fma_f32 v[184:185], v[184:185], v[78:79], v[160:161] op_sel_hi:[1,0,1]
    v_pk_fma_f32 v[186:187], v[186:187], v[78:79], v[162:163] op_sel_hi:[1,0,1]
    v_cvt_pk_bf16_f32 v144, v180, v181
    v_cvt_pk_bf16_f32 v145, v182, v183
    v_cvt_pk_bf16_f32 v146, v184, v185
    v_cvt_pk_bf16_f32 v147, v186, v187
    s_nop 0
    v_permlane16_swap_b32 v144, v146
    v_permlane16_swap_b32 v145, v147
    buffer_store_dwordx4 v[144:147], v35, s[32:35], s60 offen offset:1024 sc1
    v_pk_mul_f32 v[156:157], v[84:85], v[72:73] op_sel:[0,1] op_sel_hi:[1,1]
    v_pk_mul_f32 v[158:159], v[86:87], v[72:73] op_sel:[0,1] op_sel_hi:[1,1]
    v_pk_fma_f32 v[188:189], v[188:189], v[72:73], v[156:157] op_sel_hi:[1,0,1]
    v_pk_fma_f32 v[190:191], v[190:191], v[72:73], v[158:159] op_sel_hi:[1,0,1]
    v_pk_mul_f32 v[160:161], v[84:85], v[74:75] op_sel:[0,1] op_sel_hi:[1,1]
    v_pk_mul_f32 v[162:163], v[86:87], v[74:75] op_sel:[0,1] op_sel_hi:[1,1]
    v_pk_fma_f32 v[192:193], v[192:193], v[74:75], v[160:161] op_sel_hi:[1,0,1]
    v_pk_fma_f32 v[194:195], v[194:195], v[74:75], v[162:163] op_sel_hi:[1,0,1]
    v_cvt_pk_bf16_f32 v148, v188, v189
    v_cvt_pk_bf16_f32 v149, v190, v191
    v_cvt_pk_bf16_f32 v150, v192, v193
    v_cvt_pk_bf16_f32 v151, v194, v195
    s_nop 0
    v_permlane16_swap_b32 v148, v150
    v_permlane16_swap_b32 v149, v151
    buffer_store_dwordx4 v[148:151], v35, s[32:35], s53 offen offset:0 sc1
    v_pk_mul_f32 v[156:157], v[84:85], v[76:77] op_sel:[0,1] op_sel_hi:[1,1]
    v_pk_mul_f32 v[158:159], v[86:87], v[76:77] op_sel:[0,1] op_sel_hi:[1,1]
    v_pk_fma_f32 v[196:197], v[196:197], v[76:77], v[156:157] op_sel_hi:[1,0,1]
    v_pk_fma_f32 v[198:199], v[198:199], v[76:77], v[158:159] op_sel_hi:[1,0,1]
    v_pk_mul_f32 v[160:161], v[84:85], v[78:79] op_sel:[0,1] op_sel_hi:[1,1]
    v_pk_mul_f32 v[162:163], v[86:87], v[78:79] op_sel:[0,1] op_sel_hi:[1,1]
    v_pk_fma_f32 v[200:201], v[200:201], v[78:79], v[160:161] op_sel_hi:[1,0,1]
    v_pk_fma_f32 v[202:203], v[202:203], v[78:79], v[162:163] op_sel_hi:[1,0,1]
    v_cvt_pk_bf16_f32 v152, v196, v197
    v_cvt_pk_bf16_f32 v153, v198, v199
    v_cvt_pk_bf16_f32 v154, v200, v201
    v_cvt_pk_bf16_f32 v155, v202, v203
    s_nop 0
    v_permlane16_swap_b32 v152, v154
    v_permlane16_swap_b32 v153, v155
    buffer_store_dwordx4 v[152:155], v35, s[32:35], s53 offen offset:1024 sc1
    s_cmp_lg_u32 s59, 0
    s_nop 0
    s_cbranch_scc1 L_light_3
    v_pk_fma_f32 v[244:245], v[88:89], v[72:73], v[56:57] op_sel:[0,1,0] op_sel_hi:[1,1,1]
    v_pk_fma_f32 v[246:247], v[90:91], v[72:73], v[58:59] op_sel:[0,1,0] op_sel_hi:[1,1,1]
    v_pk_fma_f32 v[204:205], v[204:205], v[72:73], v[244:245] op_sel_hi:[1,0,1]
    v_pk_fma_f32 v[206:207], v[206:207], v[72:73], v[246:247] op_sel_hi:[1,0,1]
    v_max_f32 v204, 0, v204
    v_max_f32 v205, 0, v205
    v_max_f32 v206, 0, v206
    v_max_f32 v207, 0, v207
    v_pk_mul_f32 v[204:205], v[204:205], v[204:205]
    v_pk_mul_f32 v[206:207], v[206:207], v[206:207]
    v_cvt_pk_bf16_f32 v236, v204, v205
    v_cvt_pk_bf16_f32 v237, v206, v207
    v_pk_fma_f32 v[244:245], v[92:93], v[72:73], v[60:61] op_sel:[0,1,0] op_sel_hi:[1,1,1]
    v_pk_fma_f32 v[246:247], v[94:95], v[72:73], v[62:63] op_sel:[0,1,0] op_sel_hi:[1,1,1]
    v_pk_fma_f32 v[220:221], v[220:221], v[72:73], v[244:245] op_sel_hi:[1,0,1]
    v_pk_fma_f32 v[222:223], v[222:223], v[72:73], v[246:247] op_sel_hi:[1,0,1]
    v_max_f32 v220, 0, v220
    v_max_f32 v221, 0, v221
    v_max_f32 v222, 0, v222
    v_max_f32 v223, 0, v223
    v_pk_mul_f32 v[220:221], v[220:221], v[220:221]
    v_pk_mul_f32 v[222:223], v[222:223], v[222:223]
    v_cvt_pk_bf16_f32 v238, v220, v221
    v_cvt_pk_bf16_f32 v239, v222, v223
    buffer_store_dwordx4 v[236:239], v1, s[32:35], s61 offen offset:0 sc1
    v_pk_fma_f32 v[244:245], v[88:89], v[74:75], v[56:57] op_sel:[0,1,0] op_sel_hi:[1,1,1]
    v_pk_fma_f32 v[246:247], v[90:91], v[74:75], v[58:59] op_sel:[0,1,0] op_sel_hi:[1,1,1]
    v_pk_fma_f32 v[208:209], v[208:209], v[74:75], v[244:245] op_sel_hi:[1,0,1]
    v_pk_fma_f32 v[210:211], v[210:211], v[74:75], v[246:247] op_sel_hi:[1,0,1]
    v_max_f32 v208, 0, v208
    v_max_f32 v209, 0, v209
    v_max_f32 v210, 0, v210
    v_max_f32 v211, 0, v211
    v_pk_mul_f32 v[208:209], v[208:209], v[208:209]
    v_pk_mul_f32 v[210:211], v[210:211], v[210:211]
    v_cvt_pk_bf16_f32 v240, v208, v209
    v_cvt_pk_bf16_f32 v241, v210, v211
    v_pk_fma_f32 v[244:245], v[92:93], v[74:75], v[60:61] op_sel:[0,1,0] op_sel_hi:[1,1,1]
    v_pk_fma_f32 v[246:247], v[94:95], v[74:75], v[62:63] op_sel:[0,1,0] op_sel_hi:[1,1,1]
    v_pk_fma_f32 v[224:225], v[224:225], v[74:75], v[244:245] op_sel_hi:[1,0,1]
    v_pk_fma_f32 v[226:227], v[226:227], v[74:75], v[246:247] op_sel_hi:[1,0,1]
    v_max_f32 v224, 0, v224
    v_max_f32 v225, 0, v225
    v_max_f32 v226, 0, v226
    v_max_f32 v227, 0, v227
    v_pk_mul_f32 v[224:225], v[224:225], v[224:225]
    v_pk_mul_f32 v[226:227], v[226:227], v[226:227]
    v_cvt_pk_bf16_f32 v242, v224, v225
    v_cvt_pk_bf16_f32 v243, v226, v227
    buffer_store_dwordx4 v[240:243], v1, s[32:35], s61 offen offset:1024 sc1
    v_pk_fma_f32 v[244:245], v[88:89], v[76:77], v[56:57] op_sel:[0,1,0] op_sel_hi:[1,1,1]
    v_pk_fma_f32 v[246:247], v[90:91], v[76:77], v[58:59] op_sel:[0,1,0] op_sel_hi:[1,1,1]
    v_pk_fma_f32 v[212:213], v[212:213], v[76:77], v[244:245] op_sel_hi:[1,0,1]
    v_pk_fma_f32 v[214:215], v[214:215], v[76:77], v[246:247] op_sel_hi:[1,0,1]
    v_max_f32 v212, 0, v212
    v_max_f32 v213, 0, v213
    v_max_f32 v214, 0, v214
    v_max_f32 v215, 0, v215
    v_pk_mul_f32 v[212:213], v[212:213], v[212:213]
    v_pk_mul_f32 v[214:215], v[214:215], v[214:215]
    v_cvt_pk_bf16_f32 v236, v212, v213
    v_cvt_pk_bf16_f32 v237, v214, v215
    v_pk_fma_f32 v[244:245], v[92:93], v[76:77], v[60:61] op_sel:[0,1,0] op_sel_hi:[1,1,1]
    v_pk_fma_f32 v[246:247], v[94:95], v[76:77], v[62:63] op_sel:[0,1,0] op_sel_hi:[1,1,1]
    v_pk_fma_f32 v[228:229], v[228:229], v[76:77], v[244:245] op_sel_hi:[1,0,1]
    v_pk_fma_f32 v[230:231], v[230:231], v[76:77], v[246:247] op_sel_hi:[1,0,1]
    v_max_f32 v228, 0, v228
    v_max_f32 v229, 0, v229
    v_max_f32 v230, 0, v230
    v_max_f32 v231, 0, v231
    v_pk_mul_f32 v[228:229], v[228:229], v[228:229]
    v_pk_mul_f32 v[230:231], v[230:231], v[230:231]
    v_cvt_pk_bf16_f32 v238, v228, v229
    v_cvt_pk_bf16_f32 v239, v230, v231
    buffer_store_dwordx4 v[236:239], v1, s[32:35], s61 offen offset:2048 sc1
    v_pk_fma_f32 v[244:245], v[88:89], v[78:79], v[56:57] op_sel:[0,1,0] op_sel_hi:[1,1,1]
    v_pk_fma_f32 v[246:247], v[90:91], v[78:79], v[58:59] op_sel:[0,1,0] op_sel_hi:[1,1,1]
    v_pk_fma_f32 v[216:217], v[216:217], v[78:79], v[244:245] op_sel_hi:[1,0,1]
    v_pk_fma_f32 v[218:219], v[218:219], v[78:79], v[246:247] op_sel_hi:[1,0,1]
    v_max_f32 v216, 0, v216
    v_max_f32 v217, 0, v217
    v_max_f32 v218, 0, v218
    v_max_f32 v219, 0, v219
    v_pk_mul_f32 v[216:217], v[216:217], v[216:217]
    v_pk_mul_f32 v[218:219], v[218:219], v[218:219]
    v_cvt_pk_bf16_f32 v240, v216, v217
    v_cvt_pk_bf16_f32 v241, v218, v219
    v_pk_fma_f32 v[244:245], v[92:93], v[78:79], v[60:61] op_sel:[0,1,0] op_sel_hi:[1,1,1]
    v_pk_fma_f32 v[246:247], v[94:95], v[78:79], v[62:63] op_sel:[0,1,0] op_sel_hi:[1,1,1]
    v_pk_fma_f32 v[232:233], v[232:233], v[78:79], v[244:245] op_sel_hi:[1,0,1]
    v_pk_fma_f32 v[234:235], v[234:235], v[78:79], v[246:247] op_sel_hi:[1,0,1]
    v_max_f32 v232, 0, v232
    v_max_f32 v233, 0, v233
    v_max_f32 v234, 0, v234
    v_max_f32 v235, 0, v235
    v_pk_mul_f32 v[232:233], v[232:233], v[232:233]
    v_pk_mul_f32 v[234:235], v[234:235], v[234:235]
    v_cvt_pk_bf16_f32 v242, v232, v233
    v_cvt_pk_bf16_f32 v243, v234, v235
    buffer_store_dwordx4 v[240:243], v1, s[32:35], s61 offen offset:3072 sc1
    v_mfma_f32_16x16x32_bf16 v[172:175], v[108:111], a[0:3], 0
    v_mfma_f32_16x16x32_bf16 v[172:175], v[112:115], a[16:19], v[172:175]
    v_mfma_f32_16x16x32_bf16 v[176:179], v[108:111], a[4:7], 0
    v_mfma_f32_16x16x32_bf16 v[176:179], v[112:115], a[20:23], v[176:179]
    s_barrier
    v_mfma_f32_16x16x32_bf16 v[180:183], v[108:111], a[8:11], 0
    ds_read_b64_tr_b16 v[140:141], v25 offset:18432
    s_add_u32 m0, s52, 65536
    s_add_u32 s51, s51, 1
    s_and_b32 s51, s51, 7
    v_mfma_f32_16x16x32_bf16 v[180:183], v[112:115], a[24:27], v[180:183]
    ds_read_b64_tr_b16 v[142:143], v25 offset:18944
    s_mul_i32 s54, s51, 196608
    v_mfma_f32_16x16x32_bf16 v[184:187], v[108:111], a[12:15], 0
    buffer_load_dwordx4 v22, s[12:15], s54 offen lds
    v_mfma_f32_16x16x32_bf16 v[184:187], v[112:115], a[28:31], v[184:187]
    ds_read_b64_tr_b16 v[144:145], v25 offset:26624
    v_mfma_f32_16x16x32_bf16 v[188:191], v[116:119], a[0:3], 0
    ds_read_b64_tr_b16 v[146:147], v25 offset:27136
    s_mul_i32 s54, s51, 229376
    v_mfma_f32_16x16x32_bf16 v[188:191], v[120:123], a[16:19], v[188:191]
    buffer_load_dwordx4 v20, s[16:19], s54 offen offset:2048 lds
    v_mfma_f32_16x16x32_bf16 v[192:195], v[116:119], a[4:7], 0
    ds_read_b64_tr_b16 v[148:149], v26 offset:18432
    v_mfma_f32_16x16x32_bf16 v[192:195], v[120:123], a[20:23], v[192:195]
    ds_read_b64_tr_b16 v[150:151], v26 offset:18944
    v_mfma_f32_16x16x32_bf16 v[196:199], v[116:119], a[8:11], 0
    buffer_load_dwordx4 v21, s[16:19], s54 offen offset:3072 lds
    v_mfma_f32_16x16x32_bf16 v[196:199], v[120:123], a[24:27], v[196:199]
    ds_read_b64_tr_b16 v[152:153], v26 offset:26624
    s_add_u32 m0, s52, 49152
    v_mfma_f32_16x16x32_bf16 v[200:203], v[116:119], a[12:15], 0
    ds_read_b64_tr_b16 v[154:155], v26 offset:27136
    s_xor_b32 s100, s100, 98304
    v_mfma_f32_16x16x32_bf16 v[200:203], v[120:123], a[28:31], v[200:203]
    buffer_load_dwordx4 v8, s[20:23], s100 offen offset:0 lds
    v_mfma_f32_16x16x32_bf16 v[132:135], v[124:127], a[0:3], 0
    ds_read_b64_tr_b16 v[156:157], v27 offset:16384
    v_mfma_f32_16x16x32_bf16 v[132:135], v[128:131], a[16:19], v[132:135]
    ds_read_b64_tr_b16 v[158:159], v27 offset:16640
    v_mfma_f32_16x16x32_bf16 v[136:139], v[124:127], a[4:7], 0
    buffer_load_dwordx4 v9, s[20:23], s100 offen offset:1024 lds
    v_mfma_f32_16x16x32_bf16 v[136:139], v[128:131], a[20:23], v[136:139]
    ds_read_b64_tr_b16 v[160:161], v27 offset:24576
    v_mfma_f32_16x16x32_bf16 v[164:167], v[124:127], a[8:11], 0
    ds_read_b64_tr_b16 v[162:163], v27 offset:24832
    v_mfma_f32_16x16x32_bf16 v[164:167], v[128:131], a[24:27], v[164:167]
    buffer_load_dwordx4 v10, s[20:23], s100 offen offset:2048 lds
    v_mfma_f32_16x16x32_bf16 v[168:171], v[124:127], a[12:15], 0
    v_mfma_f32_16x16x32_bf16 v[168:171], v[128:131], a[28:31], v[168:171]
    v_smfmac_f32_16x16x64_bf16 v[96:99], v[52:55], v[108:115], v28
    buffer_load_dwordx4 v11, s[20:23], s100 offen offset:3072 lds
    v_smfmac_f32_16x16x64_bf16 v[104:107], v[52:55], v[124:131], v28
    v_lshlrev_b32 v34, 3, v0
    v_add_u32 v34, 115840, v34
    ds_write_b64 v34, v[52:53]
    s_waitcnt vmcnt(7)
    s_mov_b32 s56, 0
    s_mov_b64 exec, 1
    buffer_store_dword v2, v3, s[32:35], s56 offen sc1
    s_mov_b64 exec, -1
    s_waitcnt lgkmcnt(1)
    v_mfma_f32_16x16x32_bf16 v[172:175], v[140:143], a[32:35], v[172:175]
    v_mfma_f32_16x16x32_bf16 v[172:175], v[144:147], a[48:51], v[172:175]
    v_mfma_f32_16x16x32_bf16 v[176:179], v[140:143], a[36:39], v[176:179]
    v_mfma_f32_16x16x32_bf16 v[176:179], v[144:147], a[52:55], v[176:179]
    s_waitcnt lgkmcnt(0)
    s_barrier
    v_mfma_f32_16x16x32_bf16 v[180:183], v[140:143], a[40:43], v[180:183]
    ds_read_b64_tr_b16 v[108:109], v25 offset:34816
    s_add_u32 m0, s52, 81920
    v_mfma_f32_16x16x32_bf16 v[180:183], v[144:147], a[56:59], v[180:183]
    ds_read_b64_tr_b16 v[110:111], v25 offset:35328
    s_add_u32 s51, s51, 1
    v_mfma_f32_16x16x32_bf16 v[184:187], v[140:143], a[44:47], v[184:187]
    ds_read_b64_tr_b16 v[112:113], v25 offset:43008
    s_and_b32 s51, s51, 7
    v_mfma_f32_16x16x32_bf16 v[184:187], v[144:147], a[60:63], v[184:187]
    ds_read_b64_tr_b16 v[114:115], v25 offset:43520
    s_mul_i32 s54, s51, 196608
    v_mfma_f32_16x16x32_bf16 v[188:191], v[148:151], a[32:35], v[188:191]
    buffer_load_dwordx4 v22, s[12:15], s54 offen lds
    v_mfma_f32_16x16x32_bf16 v[188:191], v[152:155], a[48:51], v[188:191]
    v_mfma_f32_16x16x32_bf16 v[192:195], v[148:151], a[36:39], v[192:195]
    ds_read_b64_tr_b16 v[116:117], v26 offset:34816
    v_mfma_f32_16x16x32_bf16 v[192:195], v[152:155], a[52:55], v[192:195]
    ds_read_b64_tr_b16 v[118:119], v26 offset:35328
    v_mfma_f32_16x16x32_bf16 v[196:199], v[148:151], a[40:43], v[196:199]
    ds_read_b64_tr_b16 v[120:121], v26 offset:43008
    v_mfma_f32_16x16x32_bf16 v[196:199], v[152:155], a[56:59], v[196:199]
    ds_read_b64_tr_b16 v[122:123], v26 offset:43520
    v_mfma_f32_16x16x32_bf16 v[200:203], v[148:151], a[44:47], v[200:203]
    s_mul_i32 s54, s51, 229376
    v_mfma_f32_16x16x32_bf16 v[200:203], v[152:155], a[60:63], v[200:203]
    buffer_load_dwordx4 v20, s[16:19], s54 offen offset:2048 lds
    v_mfma_f32_16x16x32_bf16 v[132:135], v[156:159], a[32:35], v[132:135]
    ds_read_b64_tr_b16 v[124:125], v27 offset:32768
    v_mfma_f32_16x16x32_bf16 v[132:135], v[160:163], a[48:51], v[132:135]
    ds_read_b64_tr_b16 v[126:127], v27 offset:33024
    v_mfma_f32_16x16x32_bf16 v[136:139], v[156:159], a[36:39], v[136:139]
    ds_read_b64_tr_b16 v[128:129], v27 offset:40960
    v_mfma_f32_16x16x32_bf16 v[136:139], v[160:163], a[52:55], v[136:139]
    ds_read_b64_tr_b16 v[130:131], v27 offset:41216
    v_mfma_f32_16x16x32_bf16 v[164:167], v[156:159], a[40:43], v[164:167]
    v_mfma_f32_16x16x32_bf16 v[164:167], v[160:163], a[56:59], v[164:167]
    v_mfma_f32_16x16x32_bf16 v[168:171], v[156:159], a[44:47], v[168:171]
    buffer_load_dwordx4 v21, s[16:19], s54 offen offset:3072 lds
    v_mfma_f32_16x16x32_bf16 v[168:171], v[160:163], a[60:63], v[168:171]
    v_smfmac_f32_16x16x64_bf16 v[96:99], v[52:55], v[140:147], v28
    v_smfmac_f32_16x16x64_bf16 v[104:107], v[52:55], v[156:163], v28
    s_waitcnt lgkmcnt(3)
    v_mfma_f32_16x16x32_bf16 v[172:175], v[108:111], a[64:67], v[172:175]
    v_mfma_f32_16x16x32_bf16 v[172:175], v[112:115], a[80:83], v[172:175]
    v_mfma_f32_16x16x32_bf16 v[176:179], v[108:111], a[68:71], v[176:179]
    v_mfma_f32_16x16x32_bf16 v[176:179], v[112:115], a[84:87], v[176:179]
    s_waitcnt lgkmcnt(0)
    s_barrier
    v_mfma_f32_16x16x32_bf16 v[180:183], v[108:111], a[72:75], v[180:183]
    ds_read_b64_tr_b16 v[140:141], v25 offset:51200
    s_add_u32 m0, s52, 98304
    v_mfma_f32_16x16x32_bf16 v[180:183], v[112:115], a[88:91], v[180:183]
    ds_read_b64_tr_b16 v[142:143], v25 offset:51712
    s_add_u32 s51, s51, 1
    v_mfma_f32_16x16x32_bf16 v[184:187], v[108:111], a[76:79], v[184:187]
    ds_read_b64_tr_b16 v[144:145], v25 offset:59392
    s_and_b32 s51, s51, 7
    v_mfma_f32_16x16x32_bf16 v[184:187], v[112:115], a[92:95], v[184:187]
    ds_read_b64_tr_b16 v[146:147], v25 offset:59904
    s_mul_i32 s54, s51, 196608
    v_mfma_f32_16x16x32_bf16 v[188:191], v[116:119], a[64:67], v[188:191]
    buffer_load_dwordx4 v22, s[12:15], s54 offen lds
    v_mfma_f32_16x16x32_bf16 v[188:191], v[120:123], a[80:83], v[188:191]
    v_mfma_f32_16x16x32_bf16 v[192:195], v[116:119], a[68:71], v[192:195]
    ds_read_b64_tr_b16 v[148:149], v26 offset:51200
    v_mfma_f32_16x16x32_bf16 v[192:195], v[120:123], a[84:87], v[192:195]
    ds_read_b64_tr_b16 v[150:151], v26 offset:51712
    v_mfma_f32_16x16x32_bf16 v[196:199], v[116:119], a[72:75], v[196:199]
    ds_read_b64_tr_b16 v[152:153], v26 offset:59392
    v_mfma_f32_16x16x32_bf16 v[196:199], v[120:123], a[88:91], v[196:199]
    ds_read_b64_tr_b16 v[154:155], v26 offset:59904
    v_mfma_f32_16x16x32_bf16 v[200:203], v[116:119], a[76:79], v[200:203]
    s_mul_i32 s54, s51, 229376
    v_mfma_f32_16x16x32_bf16 v[200:203], v[120:123], a[92:95], v[200:203]
    buffer_load_dwordx4 v20, s[16:19], s54 offen offset:2048 lds
    v_mfma_f32_16x16x32_bf16 v[132:135], v[124:127], a[64:67], v[132:135]
    ds_read_b64_tr_b16 v[156:157], v27 offset:49152
    v_mfma_f32_16x16x32_bf16 v[132:135], v[128:131], a[80:83], v[132:135]
    ds_read_b64_tr_b16 v[158:159], v27 offset:49408
    v_mfma_f32_16x16x32_bf16 v[136:139], v[124:127], a[68:71], v[136:139]
    ds_read_b64_tr_b16 v[160:161], v27 offset:57344
    v_mfma_f32_16x16x32_bf16 v[136:139], v[128:131], a[84:87], v[136:139]
    ds_read_b64_tr_b16 v[162:163], v27 offset:57600
    v_mfma_f32_16x16x32_bf16 v[164:167], v[124:127], a[72:75], v[164:167]
    v_mfma_f32_16x16x32_bf16 v[164:167], v[128:131], a[88:91], v[164:167]
    v_mfma_f32_16x16x32_bf16 v[168:171], v[124:127], a[76:79], v[168:171]
    buffer_load_dwordx4 v21, s[16:19], s54 offen offset:3072 lds
    v_mfma_f32_16x16x32_bf16 v[168:171], v[128:131], a[92:95], v[168:171]
    v_smfmac_f32_16x16x64_bf16 v[96:99], v[52:55], v[108:115], v28
    v_smfmac_f32_16x16x64_bf16 v[104:107], v[52:55], v[124:131], v28
    s_waitcnt lgkmcnt(3)
    v_mfma_f32_16x16x32_bf16 v[172:175], v[140:143], a[96:99], v[172:175]
    v_mfma_f32_16x16x32_bf16 v[172:175], v[144:147], a[112:115], v[172:175]
    v_mfma_f32_16x16x32_bf16 v[176:179], v[140:143], a[100:103], v[176:179]
    v_mfma_f32_16x16x32_bf16 v[176:179], v[144:147], a[116:119], v[176:179]
    s_waitcnt vmcnt(11) lgkmcnt(0)
    s_barrier
    v_mfma_f32_16x16x32_bf16 v[180:183], v[140:143], a[104:107], v[180:183]
    ds_read_b64_tr_b16 v[108:109], v25 offset:2048
    s_add_u32 m0, s52, 114688
    v_mfma_f32_16x16x32_bf16 v[180:183], v[144:147], a[120:123], v[180:183]
    ds_read_b64_tr_b16 v[110:111], v25 offset:2560
    s_add_u32 s51, s51, 1
    v_mfma_f32_16x16x32_bf16 v[184:187], v[140:143], a[108:111], v[184:187]
    ds_read_b64_tr_b16 v[112:113], v25 offset:10240
    s_and_b32 s51, s51, 7
    v_mfma_f32_16x16x32_bf16 v[184:187], v[144:147], a[124:127], v[184:187]
    ds_read_b64_tr_b16 v[114:115], v25 offset:10752
    s_mul_i32 s54, s51, 196608
    v_mfma_f32_16x16x32_bf16 v[188:191], v[148:151], a[96:99], v[188:191]
    buffer_load_dwordx4 v22, s[12:15], s54 offen lds
    v_mfma_f32_16x16x32_bf16 v[188:191], v[152:155], a[112:115], v[188:191]
    v_mfma_f32_16x16x32_bf16 v[192:195], v[148:151], a[100:103], v[192:195]
    ds_read_b64_tr_b16 v[116:117], v26 offset:2048
    v_mfma_f32_16x16x32_bf16 v[192:195], v[152:155], a[116:119], v[192:195]
    ds_read_b64_tr_b16 v[118:119], v26 offset:2560
    v_mfma_f32_16x16x32_bf16 v[196:199], v[148:151], a[104:107], v[196:199]
    ds_read_b64_tr_b16 v[120:121], v26 offset:10240
    v_mfma_f32_16x16x32_bf16 v[196:199], v[152:155], a[120:123], v[196:199]
    ds_read_b64_tr_b16 v[122:123], v26 offset:10752
    v_mfma_f32_16x16x32_bf16 v[200:203], v[148:151], a[108:111], v[200:203]
    s_mul_i32 s54, s51, 229376
    v_mfma_f32_16x16x32_bf16 v[200:203], v[152:155], a[124:127], v[200:203]
    buffer_load_dwordx4 v20, s[16:19], s54 offen offset:2048 lds
    v_mfma_f32_16x16x32_bf16 v[132:135], v[156:159], a[96:99], v[132:135]
    ds_read_b64_tr_b16 v[124:125], v27 offset:0
    v_mfma_f32_16x16x32_bf16 v[132:135], v[160:163], a[112:115], v[132:135]
    ds_read_b64_tr_b16 v[126:127], v27 offset:256
    v_mfma_f32_16x16x32_bf16 v[136:139], v[156:159], a[100:103], v[136:139]
    ds_read_b64_tr_b16 v[128:129], v27 offset:8192
    v_mfma_f32_16x16x32_bf16 v[136:139], v[160:163], a[116:119], v[136:139]
    ds_read_b64_tr_b16 v[130:131], v27 offset:8448
    v_mfma_f32_16x16x32_bf16 v[164:167], v[156:159], a[104:107], v[164:167]
    v_mfma_f32_16x16x32_bf16 v[164:167], v[160:163], a[120:123], v[164:167]
    v_mfma_f32_16x16x32_bf16 v[168:171], v[156:159], a[108:111], v[168:171]
    buffer_load_dwordx4 v21, s[16:19], s54 offen offset:3072 lds
    v_mfma_f32_16x16x32_bf16 v[168:171], v[160:163], a[124:127], v[168:171]
    v_smfmac_f32_16x16x64_bf16 v[96:99], v[52:55], v[140:147], v28
    v_smfmac_f32_16x16x64_bf16 v[104:107], v[52:55], v[156:163], v28
    buffer_load_dword v7, v5, s[32:35], 0 offen sc1
    s_waitcnt lgkmcnt(3)
    v_mfma_f32_16x16x32_bf16 v[172:175], v[108:111], a[128:131], v[172:175]
    v_mfma_f32_16x16x32_bf16 v[172:175], v[112:115], a[144:147], v[172:175]
    v_mfma_f32_16x16x32_bf16 v[176:179], v[108:111], a[132:135], v[176:179]
    v_mfma_f32_16x16x32_bf16 v[176:179], v[112:115], a[148:151], v[176:179]
    s_waitcnt vmcnt(7) lgkmcnt(0)
    s_barrier
    v_mfma_f32_16x16x32_bf16 v[180:183], v[108:111], a[136:139], v[180:183]
    ds_read_b64_tr_b16 v[140:141], v25 offset:18432
    v_mfma_f32_16x16x32_bf16 v[180:183], v[112:115], a[152:155], v[180:183]
    ds_read_b64_tr_b16 v[142:143], v25 offset:18944
    s_add_u32 m0, s52, 65536
    v_mfma_f32_16x16x32_bf16 v[184:187], v[108:111], a[140:143], v[184:187]
    ds_read_b64_tr_b16 v[144:145], v25 offset:26624
    s_xor_b32 s100, s100, 32768
    v_mfma_f32_16x16x32_bf16 v[184:187], v[112:115], a[156:159], v[184:187]
    buffer_load_dwordx4 v8, s[20:23], s100 offen offset:0 lds
    v_mfma_f32_16x16x32_bf16 v[188:191], v[116:119], a[128:131], v[188:191]
    ds_read_b64_tr_b16 v[146:147], v25 offset:27136
    v_mfma_f32_16x16x32_bf16 v[188:191], v[120:123], a[144:147], v[188:191]
    ds_read_b64_tr_b16 v[148:149], v26 offset:18432
    v_mfma_f32_16x16x32_bf16 v[192:195], v[116:119], a[132:135], v[192:195]
    ds_read_b64_tr_b16 v[150:151], v26 offset:18944
    v_mfma_f32_16x16x32_bf16 v[192:195], v[120:123], a[148:151], v[192:195]
    v_mfma_f32_16x16x32_bf16 v[196:199], v[116:119], a[136:139], v[196:199]
    buffer_load_dwordx4 v9, s[20:23], s100 offen offset:1024 lds
    v_mfma_f32_16x16x32_bf16 v[196:199], v[120:123], a[152:155], v[196:199]
    ds_read_b64_tr_b16 v[152:153], v26 offset:26624
    v_mfma_f32_16x16x32_bf16 v[200:203], v[116:119], a[140:143], v[200:203]
    ds_read_b64_tr_b16 v[154:155], v26 offset:27136
    v_mfma_f32_16x16x32_bf16 v[200:203], v[120:123], a[156:159], v[200:203]
    ds_read_b64_tr_b16 v[156:157], v27 offset:16384
    v_mfma_f32_16x16x32_bf16 v[132:135], v[124:127], a[128:131], v[132:135]
    ds_read_b64_tr_b16 v[158:159], v27 offset:16640
    v_mfma_f32_16x16x32_bf16 v[132:135], v[128:131], a[144:147], v[132:135]
    ds_read_b64_tr_b16 v[160:161], v27 offset:24576
    v_mfma_f32_16x16x32_bf16 v[136:139], v[124:127], a[132:135], v[136:139]
    buffer_load_dwordx4 v10, s[20:23], s100 offen offset:2048 lds
    v_mfma_f32_16x16x32_bf16 v[136:139], v[128:131], a[148:151], v[136:139]
    ds_read_b64_tr_b16 v[162:163], v27 offset:24832
    v_mfma_f32_16x16x32_bf16 v[164:167], v[124:127], a[136:139], v[164:167]
    v_mfma_f32_16x16x32_bf16 v[164:167], v[128:131], a[152:155], v[164:167]
    v_mfma_f32_16x16x32_bf16 v[168:171], v[124:127], a[140:143], v[168:171]
    v_mfma_f32_16x16x32_bf16 v[168:171], v[128:131], a[156:159], v[168:171]
    buffer_load_dwordx4 v11, s[20:23], s100 offen offset:3072 lds
    v_smfmac_f32_16x16x64_bf16 v[96:99], v[52:55], v[108:115], v28
    v_smfmac_f32_16x16x64_bf16 v[104:107], v[52:55], v[124:131], v28
    s_waitcnt lgkmcnt(2)
    v_mfma_f32_16x16x32_bf16 v[172:175], v[140:143], a[160:163], v[172:175]
    v_mfma_f32_16x16x32_bf16 v[172:175], v[144:147], a[176:179], v[172:175]
    v_mfma_f32_16x16x32_bf16 v[176:179], v[140:143], a[164:167], v[176:179]
    v_mfma_f32_16x16x32_bf16 v[176:179], v[144:147], a[180:183], v[176:179]
    s_waitcnt vmcnt(8) lgkmcnt(0)
    s_barrier
    v_mfma_f32_16x16x32_bf16 v[180:183], v[140:143], a[168:171], v[180:183]
    ds_read_b64_tr_b16 v[108:109], v25 offset:34816
    v_mfma_f32_16x16x32_bf16 v[180:183], v[144:147], a[184:187], v[180:183]
    ds_read_b64_tr_b16 v[110:111], v25 offset:35328
    s_add_u32 m0, s52, 81920
    v_mfma_f32_16x16x32_bf16 v[184:187], v[140:143], a[172:175], v[184:187]
    ds_read_b64_tr_b16 v[112:113], v25 offset:43008
    s_xor_b32 s100, s100, 229376
    v_mfma_f32_16x16x32_bf16 v[184:187], v[144:147], a[188:191], v[184:187]
    buffer_load_dwordx4 v8, s[20:23], s100 offen offset:0 lds
    v_mfma_f32_16x16x32_bf16 v[188:191], v[148:151], a[160:163], v[188:191]
    ds_read_b64_tr_b16 v[114:115], v25 offset:43520
    v_mfma_f32_16x16x32_bf16 v[188:191], v[152:155], a[176:179], v[188:191]
    ds_read_b64_tr_b16 v[116:117], v26 offset:34816
    v_mfma_f32_16x16x32_bf16 v[192:195], v[148:151], a[164:167], v[192:195]
    ds_read_b64_tr_b16 v[118:119], v26 offset:35328
    v_mfma_f32_16x16x32_bf16 v[192:195], v[152:155], a[180:183], v[192:195]
    v_mfma_f32_16x16x32_bf16 v[196:199], v[148:151], a[168:171], v[196:199]
    buffer_load_dwordx4 v9, s[20:23], s100 offen offset:1024 lds
    v_mfma_f32_16x16x32_bf16 v[196:199], v[152:155], a[184:187], v[196:199]
    ds_read_b64_tr_b16 v[120:121], v26 offset:43008
    v_mfma_f32_16x16x32_bf16 v[200:203], v[148:151], a[172:175], v[200:203]
    ds_read_b64_tr_b16 v[122:123], v26 offset:43520
    v_mfma_f32_16x16x32_bf16 v[200:203], v[152:155], a[188:191], v[200:203]
    ds_read_b64_tr_b16 v[124:125], v27 offset:32768
    v_mfma_f32_16x16x32_bf16 v[132:135], v[156:159], a[160:163], v[132:135]
    ds_read_b64_tr_b16 v[126:127], v27 offset:33024
    v_mfma_f32_16x16x32_bf16 v[132:135], v[160:163], a[176:179], v[132:135]
    ds_read_b64_tr_b16 v[128:129], v27 offset:40960
    v_mfma_f32_16x16x32_bf16 v[136:139], v[156:159], a[164:167], v[136:139]
    buffer_load_dwordx4 v10, s[20:23], s100 offen offset:2048 lds
    v_mfma_f32_16x16x32_bf16 v[136:139], v[160:163], a[180:183], v[136:139]
    ds_read_b64_tr_b16 v[130:131], v27 offset:41216
    v_mfma_f32_16x16x32_bf16 v[164:167], v[156:159], a[168:171], v[164:167]
    v_mfma_f32_16x16x32_bf16 v[164:167], v[160:163], a[184:187], v[164:167]
    v_mfma_f32_16x16x32_bf16 v[168:171], v[156:159], a[172:175], v[168:171]
    v_mfma_f32_16x16x32_bf16 v[168:171], v[160:163], a[188:191], v[168:171]
    buffer_load_dwordx4 v11, s[20:23], s100 offen offset:3072 lds
    v_smfmac_f32_16x16x64_bf16 v[96:99], v[52:55], v[140:147], v28
    v_smfmac_f32_16x16x64_bf16 v[104:107], v[52:55], v[156:163], v28
    s_waitcnt vmcnt(8)
    v_cmp_ne_u32 vcc, s49, v7
    s_nop 0
    s_cbranch_vccnz L_poll_retry_7
L_poll_ok_8:
    s_waitcnt lgkmcnt(0)
    v_mfma_f32_16x16x32_bf16 v[172:175], v[108:111], a[192:195], v[172:175]
    v_mfma_f32_16x16x32_bf16 v[172:175], v[112:115], a[208:211], v[172:175]
    v_mfma_f32_16x16x32_bf16 v[176:179], v[108:111], a[196:199], v[176:179]
    v_mfma_f32_16x16x32_bf16 v[176:179], v[112:115], a[212:215], v[176:179]
    s_barrier
    v_mfma_f32_16x16x32_bf16 v[180:183], v[108:111], a[200:203], v[180:183]
    ds_read_b64_tr_b16 v[140:141], v25 offset:51200
    s_add_u32 m0, s99, 0
    v_mfma_f32_16x16x32_bf16 v[180:183], v[112:115], a[216:219], v[180:183]
    ds_read_b64_tr_b16 v[142:143], v25 offset:51712
    buffer_load_dwordx4 v1, s[32:35], s96 offen offset:0 sc1 lds
    v_mfma_f32_16x16x32_bf16 v[184:187], v[108:111], a[204:207], v[184:187]
    ds_read_b64_tr_b16 v[144:145], v25 offset:59392
    s_add_u32 s96, s96, 64512
    v_mfma_f32_16x16x32_bf16 v[184:187], v[112:115], a[220:223], v[184:187]
    ds_read_b64_tr_b16 v[146:147], v25 offset:59904
    buffer_load_dwordx4 v1, s[32:35], s96 offen offset:1024 sc1 lds
    v_mfma_f32_16x16x32_bf16 v[188:191], v[116:119], a[192:195], v[188:191]
    ds_read_b64_tr_b16 v[148:149], v26 offset:51200
    s_add_u32 s96, s96, 2030592
    v_mfma_f32_16x16x32_bf16 v[188:191], v[120:123], a[208:211], v[188:191]
    buffer_load_dwordx4 v1, s[32:35], s96 offen offset:2048 sc1 lds
    v_mfma_f32_16x16x32_bf16 v[192:195], v[116:119], a[196:199], v[192:195]
    ds_read_b64_tr_b16 v[150:151], v26 offset:51712
    s_add_u32 s96, s96, 64512
    v_mfma_f32_16x16x32_bf16 v[192:195], v[120:123], a[212:215], v[192:195]
    buffer_load_dwordx4 v1, s[32:35], s96 offen offset:3072 sc1 lds
    v_mfma_f32_16x16x32_bf16 v[196:199], v[116:119], a[200:203], v[196:199]
    s_add_u32 m0, s99, 4096
    s_nop 0
    buffer_load_dwordx4 v1, s[32:35], s97 offen offset:0 sc1 lds
    v_mfma_f32_16x16x32_bf16 v[196:199], v[120:123], a[216:219], v[196:199]
    ds_read_b64_tr_b16 v[152:153], v26 offset:59392
    s_add_u32 s97, s97, 64512
    v_mfma_f32_16x16x32_bf16 v[200:203], v[116:119], a[204:207], v[200:203]
    buffer_load_dwordx4 v1, s[32:35], s97 offen offset:1024 sc1 lds
    v_mfma_f32_16x16x32_bf16 v[200:203], v[120:123], a[220:223], v[200:203]
    ds_read_b64_tr_b16 v[154:155], v26 offset:59904
    s_add_u32 s97, s97, 2030592
    v_mfma_f32_16x16x32_bf16 v[132:135], v[124:127], a[192:195], v[132:135]
    buffer_load_dwordx4 v1, s[32:35], s97 offen offset:2048 sc1 lds
    v_mfma_f32_16x16x32_bf16 v[132:135], v[128:131], a[208:211], v[132:135]
    ds_read_b64_tr_b16 v[156:157], v27 offset:49152
    s_add_u32 s97, s97, 64512
    v_mfma_f32_16x16x32_bf16 v[136:139], v[124:127], a[196:199], v[136:139]
    buffer_load_dwordx4 v1, s[32:35], s97 offen offset:3072 sc1 lds
    v_mfma_f32_16x16x32_bf16 v[136:139], v[128:131], a[212:215], v[136:139]
    s_add_u32 m0, s52, 98304
    s_xor_b32 s100, s100, 32768
    buffer_load_dwordx4 v8, s[20:23], s100 offen offset:0 lds
    v_mfma_f32_16x16x32_bf16 v[164:167], v[124:127], a[200:203], v[164:167]
    ds_read_b64_tr_b16 v[158:159], v27 offset:49408
    v_mfma_f32_16x16x32_bf16 v[164:167], v[128:131], a[216:219], v[164:167]
    buffer_load_dwordx4 v9, s[20:23], s100 offen offset:1024 lds
    v_mfma_f32_16x16x32_bf16 v[168:171], v[124:127], a[204:207], v[168:171]
    ds_read_b64_tr_b16 v[160:161], v27 offset:57344
    v_mfma_f32_16x16x32_bf16 v[168:171], v[128:131], a[220:223], v[168:171]
    buffer_load_dwordx4 v10, s[20:23], s100 offen offset:2048 lds
    v_smfmac_f32_16x16x64_bf16 v[96:99], v[52:55], v[108:115], v28
    ds_read_b64_tr_b16 v[162:163], v27 offset:57600
    v_smfmac_f32_16x16x64_bf16 v[104:107], v[52:55], v[124:131], v28
    buffer_load_dwordx4 v11, s[20:23], s100 offen offset:3072 lds
    s_waitcnt lgkmcnt(3)
    v_smfmac_f32_16x16x64_bf16 v[96:99], v[52:55], v[140:147], v28
    s_waitcnt lgkmcnt(0)
    v_smfmac_f32_16x16x64_bf16 v[104:107], v[52:55], v[156:163], v28
    v_mfma_f32_16x16x32_bf16 v[172:175], v[140:143], a[224:227], v[172:175]
    v_mfma_f32_16x16x32_bf16 v[172:175], v[144:147], a[240:243], v[172:175]
    v_mfma_f32_16x16x32_bf16 v[176:179], v[140:143], a[228:231], v[176:179]
    v_mfma_f32_16x16x32_bf16 v[176:179], v[144:147], a[244:247], v[176:179]
    v_mfma_f32_16x16x32_bf16 v[180:183], v[140:143], a[232:235], v[180:183]
    v_mfma_f32_16x16x32_bf16 v[180:183], v[144:147], a[248:251], v[180:183]
    v_mfma_f32_16x16x32_bf16 v[184:187], v[140:143], a[236:239], v[184:187]
    s_nop 2
    v_add_f32 v96, v96, v97
    ds_write_b32 v31, v96 offset:50944
    v_mfma_f32_16x16x32_bf16 v[184:187], v[144:147], a[252:255], v[184:187]
    v_add_f32 v104, v104, v105
    ds_write_b32 v31, v104 offset:51072
    v_mfma_f32_16x16x32_bf16 v[188:191], v[148:151], a[224:227], v[188:191]
    v_mfma_f32_16x16x32_bf16 v[188:191], v[152:155], a[240:243], v[188:191]
    v_mfma_f32_16x16x32_bf16 v[192:195], v[148:151], a[228:231], v[192:195]
    v_mfma_f32_16x16x32_bf16 v[192:195], v[152:155], a[244:247], v[192:195]
    s_waitcnt lgkmcnt(0)
    s_barrier
    v_mfma_f32_16x16x32_bf16 v[196:199], v[148:151], a[232:235], v[196:199]
    ds_read_b128 v[96:99], v32 offset:50944
    v_mfma_f32_16x16x32_bf16 v[196:199], v[152:155], a[248:251], v[196:199]
    ds_read_b128 v[100:103], v29 offset:51008
    s_add_u32 m0, s99, 8192
    v_mfma_f32_16x16x32_bf16 v[200:203], v[148:151], a[236:239], v[200:203]
    buffer_load_dwordx4 v1, s[32:35], s98 offen offset:0 sc1 lds
    v_mfma_f32_16x16x32_bf16 v[200:203], v[152:155], a[252:255], v[200:203]
    v_mfma_f32_16x16x32_bf16 v[132:135], v[156:159], a[224:227], v[132:135]
    ds_read_b128 v[104:107], v32 offset:51072
    s_add_u32 s98, s98, 64512
    v_mfma_f32_16x16x32_bf16 v[132:135], v[160:163], a[240:243], v[132:135]
    buffer_load_dwordx4 v1, s[32:35], s98 offen offset:1024 sc1 lds
    v_mfma_f32_16x16x32_bf16 v[136:139], v[156:159], a[228:231], v[136:139]
    s_add_u32 s98, s98, 2030592
    v_mfma_f32_16x16x32_bf16 v[136:139], v[160:163], a[244:247], v[136:139]
    buffer_load_dwordx4 v1, s[32:35], s98 offen offset:2048 sc1 lds
    v_mfma_f32_16x16x32_bf16 v[164:167], v[156:159], a[232:235], v[164:167]
    v_mfma_f32_16x16x32_bf16 v[164:167], v[160:163], a[248:251], v[164:167]
    s_add_u32 s98, s98, 64512
    v_mfma_f32_16x16x32_bf16 v[168:171], v[156:159], a[236:239], v[168:171]
    buffer_load_dwordx4 v1, s[32:35], s98 offen offset:3072 sc1 lds
    v_mfma_f32_16x16x32_bf16 v[168:171], v[160:163], a[252:255], v[168:171]
    s_waitcnt lgkmcnt(0)
    v_pk_fma_f32 v[244:245], v[96:97], v[72:73], v[64:65] op_sel:[0,1,0] op_sel_hi:[1,1,1]
    v_pk_fma_f32 v[246:247], v[98:99], v[72:73], v[66:67] op_sel:[0,1,0] op_sel_hi:[1,1,1]
    v_pk_fma_f32 v[172:173], v[172:173], v[72:73], v[244:245] op_sel_hi:[1,0,1]
    v_pk_fma_f32 v[174:175], v[174:175], v[72:73], v[246:247] op_sel_hi:[1,0,1]
    v_max_f32 v172, 0, v172
    v_max_f32 v173, 0, v173
    v_max_f32 v174, 0, v174
    v_max_f32 v175, 0, v175
    v_pk_mul_f32 v[172:173], v[172:173], v[172:173]
    v_pk_mul_f32 v[174:175], v[174:175], v[174:175]
    v_cvt_pk_bf16_f32 v236, v172, v173
    v_cvt_pk_bf16_f32 v237, v174, v175
    v_pk_fma_f32 v[244:245], v[100:101], v[72:73], v[68:69] op_sel:[0,1,0] op_sel_hi:[1,1,1]
    v_pk_fma_f32 v[246:247], v[102:103], v[72:73], v[70:71] op_sel:[0,1,0] op_sel_hi:[1,1,1]
    v_pk_fma_f32 v[188:189], v[188:189], v[72:73], v[244:245] op_sel_hi:[1,0,1]
    v_pk_fma_f32 v[190:191], v[190:191], v[72:73], v[246:247] op_sel_hi:[1,0,1]
    v_max_f32 v188, 0, v188
    v_max_f32 v189, 0, v189
    v_max_f32 v190, 0, v190
    v_max_f32 v191, 0, v191
    v_pk_mul_f32 v[188:189], v[188:189], v[188:189]
    v_pk_mul_f32 v[190:191], v[190:191], v[190:191]
    v_cvt_pk_bf16_f32 v238, v188, v189
    v_cvt_pk_bf16_f32 v239, v190, v191
    buffer_store_dwordx4 v[236:239], v1, s[32:35], s62 offen offset:0 sc1
    v_pk_fma_f32 v[244:245], v[96:97], v[74:75], v[64:65] op_sel:[0,1,0] op_sel_hi:[1,1,1]
    v_pk_fma_f32 v[246:247], v[98:99], v[74:75], v[66:67] op_sel:[0,1,0] op_sel_hi:[1,1,1]
    v_pk_fma_f32 v[176:177], v[176:177], v[74:75], v[244:245] op_sel_hi:[1,0,1]
    v_pk_fma_f32 v[178:179], v[178:179], v[74:75], v[246:247] op_sel_hi:[1,0,1]
    v_max_f32 v176, 0, v176
    v_max_f32 v177, 0, v177
    v_max_f32 v178, 0, v178
    v_max_f32 v179, 0, v179
    v_pk_mul_f32 v[176:177], v[176:177], v[176:177]
    v_pk_mul_f32 v[178:179], v[178:179], v[178:179]
    v_cvt_pk_bf16_f32 v240, v176, v177
    v_cvt_pk_bf16_f32 v241, v178, v179
    v_pk_fma_f32 v[244:245], v[100:101], v[74:75], v[68:69] op_sel:[0,1,0] op_sel_hi:[1,1,1]
    v_pk_fma_f32 v[246:247], v[102:103], v[74:75], v[70:71] op_sel:[0,1,0] op_sel_hi:[1,1,1]
    v_pk_fma_f32 v[192:193], v[192:193], v[74:75], v[244:245] op_sel_hi:[1,0,1]
    v_pk_fma_f32 v[194:195], v[194:195], v[74:75], v[246:247] op_sel_hi:[1,0,1]
    v_max_f32 v192, 0, v192
    v_max_f32 v193, 0, v193
    v_max_f32 v194, 0, v194
    v_max_f32 v195, 0, v195
    v_pk_mul_f32 v[192:193], v[192:193], v[192:193]
    v_pk_mul_f32 v[194:195], v[194:195], v[194:195]
    v_cvt_pk_bf16_f32 v242, v192, v193
    v_cvt_pk_bf16_f32 v243, v194, v195
    buffer_store_dwordx4 v[240:243], v1, s[32:35], s62 offen offset:1024 sc1
    v_pk_fma_f32 v[244:245], v[96:97], v[76:77], v[64:65] op_sel:[0,1,0] op_sel_hi:[1,1,1]
    v_pk_fma_f32 v[246:247], v[98:99], v[76:77], v[66:67] op_sel:[0,1,0] op_sel_hi:[1,1,1]
    v_pk_fma_f32 v[180:181], v[180:181], v[76:77], v[244:245] op_sel_hi:[1,0,1]
    v_pk_fma_f32 v[182:183], v[182:183], v[76:77], v[246:247] op_sel_hi:[1,0,1]
    v_max_f32 v180, 0, v180
    v_max_f32 v181, 0, v181
    v_max_f32 v182, 0, v182
    v_max_f32 v183, 0, v183
    v_pk_mul_f32 v[180:181], v[180:181], v[180:181]
    v_pk_mul_f32 v[182:183], v[182:183], v[182:183]
    v_cvt_pk_bf16_f32 v236, v180, v181
    v_cvt_pk_bf16_f32 v237, v182, v183
    v_pk_fma_f32 v[244:245], v[100:101], v[76:77], v[68:69] op_sel:[0,1,0] op_sel_hi:[1,1,1]
    v_pk_fma_f32 v[246:247], v[102:103], v[76:77], v[70:71] op_sel:[0,1,0] op_sel_hi:[1,1,1]
    v_pk_fma_f32 v[196:197], v[196:197], v[76:77], v[244:245] op_sel_hi:[1,0,1]
    v_pk_fma_f32 v[198:199], v[198:199], v[76:77], v[246:247] op_sel_hi:[1,0,1]
    v_max_f32 v196, 0, v196
    v_max_f32 v197, 0, v197
    v_max_f32 v198, 0, v198
    v_max_f32 v199, 0, v199
    v_pk_mul_f32 v[196:197], v[196:197], v[196:197]
    v_pk_mul_f32 v[198:199], v[198:199], v[198:199]
    v_cvt_pk_bf16_f32 v238, v196, v197
    v_cvt_pk_bf16_f32 v239, v198, v199
    buffer_store_dwordx4 v[236:239], v1, s[32:35], s62 offen offset:2048 sc1
    v_pk_fma_f32 v[244:245], v[96:97], v[78:79], v[64:65] op_sel:[0,1,0] op_sel_hi:[1,1,1]
    v_pk_fma_f32 v[246:247], v[98:99], v[78:79], v[66:67] op_sel:[0,1,0] op_sel_hi:[1,1,1]
    v_pk_fma_f32 v[184:185], v[184:185], v[78:79], v[244:245] op_sel_hi:[1,0,1]
    v_pk_fma_f32 v[186:187], v[186:187], v[78:79], v[246:247] op_sel_hi:[1,0,1]
    v_max_f32 v184, 0, v184
    v_max_f32 v185, 0, v185
    v_max_f32 v186, 0, v186
    v_max_f32 v187, 0, v187
    v_pk_mul_f32 v[184:185], v[184:185], v[184:185]
    v_pk_mul_f32 v[186:187], v[186:187], v[186:187]
    v_cvt_pk_bf16_f32 v240, v184, v185
    v_cvt_pk_bf16_f32 v241, v186, v187
    v_pk_fma_f32 v[244:245], v[100:101], v[78:79], v[68:69] op_sel:[0,1,0] op_sel_hi:[1,1,1]
    v_pk_fma_f32 v[246:247], v[102:103], v[78:79], v[70:71] op_sel:[0,1,0] op_sel_hi:[1,1,1]
    v_pk_fma_f32 v[200:201], v[200:201], v[78:79], v[244:245] op_sel_hi:[1,0,1]
    v_pk_fma_f32 v[202:203], v[202:203], v[78:79], v[246:247] op_sel_hi:[1,0,1]
    v_max_f32 v200, 0, v200
    v_max_f32 v201, 0, v201
    v_max_f32 v202, 0, v202
    v_max_f32 v203, 0, v203
    v_pk_mul_f32 v[200:201], v[200:201], v[200:201]
    v_pk_mul_f32 v[202:203], v[202:203], v[202:203]
    v_cvt_pk_bf16_f32 v242, v200, v201
    v_cvt_pk_bf16_f32 v243, v202, v203
    buffer_store_dwordx4 v[240:243], v1, s[32:35], s62 offen offset:3072 sc1
    s_mov_b32 s53, 0x3eb8aa3b
    s_mov_b32 s54, 0x3eb8aa3b
    v_mul_f32 v72, s53, v72
    v_mul_f32 v73, s53, v73
    v_mul_f32 v74, s53, v74
    v_mul_f32 v75, s53, v75
    v_mul_f32 v76, s53, v76
    v_mul_f32 v77, s53, v77
    v_mul_f32 v78, s53, v78
    v_mul_f32 v79, s53, v79
    v_pk_mul_f32 v[80:81], v[104:105], v[72:73] op_sel:[0,1] op_sel_hi:[1,1]
    v_pk_mul_f32 v[82:83], v[106:107], v[72:73] op_sel:[0,1] op_sel_hi:[1,1]
    v_pk_fma_f32 v[132:133], v[132:133], v[72:73], v[80:81] op_sel_hi:[1,0,1]
    v_pk_fma_f32 v[134:135], v[134:135], v[72:73], v[82:83] op_sel_hi:[1,0,1]
    v_pk_mul_f32 v[84:85], v[104:105], v[74:75] op_sel:[0,1] op_sel_hi:[1,1]
    v_pk_mul_f32 v[86:87], v[106:107], v[74:75] op_sel:[0,1] op_sel_hi:[1,1]
    v_pk_fma_f32 v[136:137], v[136:137], v[74:75], v[84:85] op_sel_hi:[1,0,1]
    v_pk_fma_f32 v[138:139], v[138:139], v[74:75], v[86:87] op_sel_hi:[1,0,1]
    v_cvt_pk_bf16_f32 v56, v132, v133
    v_cvt_pk_bf16_f32 v57, v134, v135
    v_cvt_pk_bf16_f32 v58, v136, v137
    v_cvt_pk_bf16_f32 v59, v138, v139
    s_nop 0
    v_permlane16_swap_b32 v56, v58
    v_permlane16_swap_b32 v57, v59
    v_pk_mul_f32 v[80:81], v[104:105], v[76:77] op_sel:[0,1] op_sel_hi:[1,1]
    v_pk_mul_f32 v[82:83], v[106:107], v[76:77] op_sel:[0,1] op_sel_hi:[1,1]
    v_pk_fma_f32 v[164:165], v[164:165], v[76:77], v[80:81] op_sel_hi:[1,0,1]
    v_pk_fma_f32 v[166:167], v[166:167], v[76:77], v[82:83] op_sel_hi:[1,0,1]
    v_pk_mul_f32 v[84:85], v[104:105], v[78:79] op_sel:[0,1] op_sel_hi:[1,1]
    v_pk_mul_f32 v[86:87], v[106:107], v[78:79] op_sel:[0,1] op_sel_hi:[1,1]
    v_pk_fma_f32 v[168:169], v[168:169], v[78:79], v[84:85] op_sel_hi:[1,0,1]
    v_pk_fma_f32 v[170:171], v[170:171], v[78:79], v[86:87] op_sel_hi:[1,0,1]
    v_cvt_pk_bf16_f32 v60, v164, v165
    v_cvt_pk_bf16_f32 v61, v166, v167
    v_cvt_pk_bf16_f32 v62, v168, v169
    v_cvt_pk_bf16_f32 v63, v170, v171
    s_nop 0
    v_permlane16_swap_b32 v60, v62
    v_permlane16_swap_b32 v61, v63
    s_nop 1
L_join_4:
    s_cmp_ge_u32 s45, 2
    s_cselect_b32 s54, -1, 0
    v_mov_b32 v23, 0xffff
    v_mov_b32 v24, 0xffff0000
    v_cndmask_b32 v25, 0, v23, s[64:65]
    v_cndmask_b32 v64, v25, -1, s[66:67]
    v_bfi_b32 v72, v64, 0, s54
    v_cndmask_b32 v25, 0, v23, s[68:69]
    v_cndmask_b32 v65, v25, -1, s[70:71]
    v_bfi_b32 v73, v65, 0, s54
    v_cndmask_b32 v25, 0, v23, s[72:73]
    v_cndmask_b32 v66, v25, -1, s[74:75]
    v_bfi_b32 v74, v66, 0, s54
    v_cndmask_b32 v25, 0, v23, s[76:77]
    v_cndmask_b32 v67, v25, -1, s[78:79]
    v_bfi_b32 v75, v67, 0, s54
    v_cndmask_b32 v25, 0, v23, s[80:81]
    v_cndmask_b32 v68, v25, -1, s[82:83]
    v_bfi_b32 v76, v68, 0, s54
    v_cndmask_b32 v25, 0, v23, s[84:85]
    v_cndmask_b32 v69, v25, -1, s[86:87]
    v_bfi_b32 v77, v69, 0, s54
    v_cndmask_b32 v25, 0, v23, s[88:89]
    v_cndmask_b32 v70, v25, -1, s[90:91]
    v_bfi_b32 v78, v70, 0, s54
    v_cndmask_b32 v25, 0, v23, s[92:93]
    v_cndmask_b32 v71, v25, -1, s[94:95]
    v_bfi_b32 v79, v71, 0, s54
    s_cmp_ge_u32 s58, 8
    s_cselect_b32 s53, 0, -115712
    v_mad_i32_i24 v27, v51, s53, v37
    s_cmp_ge_u32 s58, 6
    s_cselect_b32 s53, 0, -115712
    v_mad_i32_i24 v28, v51, s53, v37
    s_cmp_ge_u32 s58, 4
    s_cselect_b32 s53, 0, -115712
    v_mad_i32_i24 v29, v51, s53, v37
    s_cmp_ge_u32 s58, 2
    s_cselect_b32 s53, 0, -115712
    v_mad_i32_i24 v30, v51, s53, v37
    v_add_u32 v14, 0x10000, v42
    v_add_u32 v18, 0x20000, v42
    v_add_u32 v15, 0x10000, v43
    v_add_u32 v19, 0x20000, v43
    v_add_u32 v16, 0x10000, v44
    v_add_u32 v20, 0x20000, v44
    v_add_u32 v17, 0x10000, v45
    v_add_u32 v21, 0x20000, v45
    s_waitcnt vmcnt(4)
    s_barrier
    ds_read_b128 a[160:163], v36 offset:32768
    ds_read_b128 a[128:131], v36 offset:0
    ds_read_b128 a[164:167], v36 offset:36864
    ds_read_b128 a[132:135], v36 offset:4096
    ds_read_b128 a[156:159], v36 offset:28672
    ds_read_b128 a[152:155], v36 offset:24576
    ds_read_b128 a[148:151], v36 offset:20480
    ds_read_b128 a[144:147], v36 offset:16384
    ds_read_b128 a[140:143], v36 offset:12288
    ds_read_b128 a[136:139], v36 offset:8192
    s_waitcnt lgkmcnt(9)
    v_mfma_f32_32x32x16_bf16 v[112:127], a[160:163], v[56:59], 0
    s_waitcnt lgkmcnt(8)
    v_mfma_f32_32x32x16_bf16 v[128:143], a[128:131], v[56:59], 0
    s_waitcnt lgkmcnt(7)
    v_mfma_f32_32x32x16_bf16 v[144:159], a[164:167], v[60:63], 0
    v_mad_u32_u24 v22, v38, 8, v37
    ds_read_b64_tr_b16 a[232:233], v22 offset:0
    ds_read_b64_tr_b16 a[234:235], v22 offset:128
    ds_read_b64_tr_b16 a[236:237], v22 offset:256
    ds_read_b64_tr_b16 a[238:239], v22 offset:384
    v_mad_u32_u24 v22, v38, 0, v27
    ds_read_b64_tr_b16 a[168:169], v22 offset:0
    ds_read_b64_tr_b16 a[170:171], v22 offset:128
    ds_read_b64_tr_b16 a[172:173], v22 offset:256
    ds_read_b64_tr_b16 a[174:175], v22 offset:384
    v_mad_u32_u24 v22, v38, 9, v37
    ds_read_b64_tr_b16 a[240:241], v22 offset:0
    ds_read_b64_tr_b16 a[242:243], v22 offset:128
    ds_read_b64_tr_b16 a[244:245], v22 offset:256
    ds_read_b64_tr_b16 a[246:247], v22 offset:384
    s_lshl2_add_u32 s101, s44, s47
    s_lshl_b32 s101, s101, 13
    buffer_load_dwordx4 a[0:3], v50, s[32:35], s101 offen offset:0 sc1
    buffer_load_dwordx4 a[4:7], v50, s[32:35], s101 offen offset:1024 sc1
    buffer_load_dwordx4 a[8:11], v50, s[32:35], s101 offen offset:2048 sc1
    buffer_load_dwordx4 a[12:15], v50, s[32:35], s101 offen offset:3072 sc1
    v_cndmask_b32 v112, v128, v112, s[64:65]
    v_mad_u32_u24 v22, v38, 1, v27
    ds_read_b64_tr_b16 a[176:177], v22 offset:0
    ds_read_b64_tr_b16 a[178:179], v22 offset:128
    ds_read_b64_tr_b16 a[180:181], v22 offset:256
    ds_read_b64_tr_b16 a[182:183], v22 offset:384
    v_cndmask_b32 v113, v129, v113, s[66:67]
    v_cndmask_b32 v114, v130, v114, s[68:69]
    v_cndmask_b32 v115, v131, v115, s[70:71]
    v_cndmask_b32 v116, v132, v116, s[72:73]
    v_cndmask_b32 v117, v133, v117, s[74:75]
    v_cndmask_b32 v118, v134, v118, s[76:77]
    v_cndmask_b32 v119, v135, v119, s[78:79]
    v_cndmask_b32 v120, v136, v120, s[80:81]
    v_mad_u32_u24 v22, v38, 7, v30
    ds_read_b64_tr_b16 a[224:225], v22 offset:0
    ds_read_b64_tr_b16 a[226:227], v22 offset:128
    ds_read_b64_tr_b16 a[228:229], v22 offset:256
    ds_read_b64_tr_b16 a[230:231], v22 offset:384
    v_cndmask_b32 v121, v137, v121, s[82:83]
    v_cndmask_b32 v122, v138, v122, s[84:85]
    v_cndmask_b32 v123, v139, v123, s[86:87]
    v_cndmask_b32 v124, v140, v124, s[88:89]
    v_cndmask_b32 v125, v141, v125, s[90:91]
    v_cndmask_b32 v126, v142, v126, s[92:93]
    v_cndmask_b32 v127, v143, v127, s[94:95]
    s_waitcnt lgkmcnt(4)
    v_mfma_f32_32x32x16_bf16 v[128:143], a[132:135], v[60:63], 0
    v_exp_f32 v112, v112
    v_mad_u32_u24 v22, v38, 6, v30
    ds_read_b64_tr_b16 a[216:217], v22 offset:0
    ds_read_b64_tr_b16 a[218:219], v22 offset:128
    ds_read_b64_tr_b16 a[220:221], v22 offset:256
    ds_read_b64_tr_b16 a[222:223], v22 offset:384
    v_exp_f32 v113, v113
    v_exp_f32 v114, v114
    v_exp_f32 v115, v115
    v_exp_f32 v116, v116
    v_mad_u32_u24 v22, v38, 5, v29
    ds_read_b64_tr_b16 a[208:209], v22 offset:0
    ds_read_b64_tr_b16 a[210:211], v22 offset:128
    ds_read_b64_tr_b16 a[212:213], v22 offset:256
    ds_read_b64_tr_b16 a[214:215], v22 offset:384
    v_exp_f32 v117, v117
    v_exp_f32 v118, v118
    v_exp_f32 v119, v119
    v_cvt_pk_bf16_f32 v160, v112, v113
    v_mad_u32_u24 v22, v38, 4, v29
    ds_read_b64_tr_b16 a[200:201], v22 offset:0
    ds_read_b64_tr_b16 a[202:203], v22 offset:128
    ds_read_b64_tr_b16 a[204:205], v22 offset:256
    ds_read_b64_tr_b16 a[206:207], v22 offset:384
    v_cvt_pk_bf16_f32 v161, v114, v115
    v_exp_f32 v120, v120
    v_exp_f32 v121, v121
    v_exp_f32 v122, v122
    v_mad_u32_u24 v22, v38, 3, v28
    ds_read_b64_tr_b16 a[192:193], v22 offset:0
    ds_read_b64_tr_b16 a[194:195], v22 offset:128
    ds_read_b64_tr_b16 a[196:197], v22 offset:256
    ds_read_b64_tr_b16 a[198:199], v22 offset:384
    v_exp_f32 v123, v123
    v_cvt_pk_bf16_f32 v162, v116, v117
    v_cvt_pk_bf16_f32 v163, v118, v119
    v_exp_f32 v124, v124
    v_mad_u32_u24 v22, v38, 2, v28
    ds_read_b64_tr_b16 a[184:185], v22 offset:0
    ds_read_b64_tr_b16 a[186:187], v22 offset:128
    ds_read_b64_tr_b16 a[188:189], v22 offset:256
    ds_read_b64_tr_b16 a[190:191], v22 offset:384
    v_exp_f32 v125, v125
    v_exp_f32 v126, v126
    v_exp_f32 v127, v127
    v_cvt_pk_bf16_f32 v164, v120, v121
    v_cvt_pk_bf16_f32 v165, v122, v123
    v_cvt_pk_bf16_f32 v166, v124, v125
    v_cvt_pk_bf16_f32 v167, v126, v127
    v_and_b32 v176, v160, v72
    v_and_b32 v160, v160, v64
    v_and_b32 v177, v161, v73
    v_and_b32 v161, v161, v65
    v_and_b32 v178, v162, v74
    v_and_b32 v162, v162, v66
    v_and_b32 v179, v163, v75
    v_and_b32 v163, v163, v67
    v_and_b32 v180, v164, v76
    v_and_b32 v164, v164, v68
    v_and_b32 v181, v165, v77
    v_and_b32 v165, v165, v69
    v_and_b32 v182, v166, v78
    v_and_b32 v166, v166, v70
    v_and_b32 v183, v167, v79
    v_and_b32 v167, v167, v71
    s_waitcnt lgkmcnt(0)
    s_barrier
    v_cndmask_b32 v144, v128, v144, s[64:65]
    v_mfma_f32_32x32x16_bf16 v[80:95], a[232:235], v[160:163], 0
    v_cndmask_b32 v145, v129, v145, s[66:67]
    s_xor_b32 s101, s101, 4096
    v_cndmask_b32 v146, v130, v146, s[68:69]
    v_cndmask_b32 v147, v131, v147, s[70:71]
    buffer_load_dwordx4 a[16:19], v50, s[32:35], s101 offen offset:0 sc1
    v_cndmask_b32 v148, v132, v148, s[72:73]
    v_cndmask_b32 v149, v133, v149, s[74:75]
    v_cndmask_b32 v150, v134, v150, s[76:77]
    v_mfma_f32_32x32x16_bf16 v[80:95], a[236:239], v[164:167], v[80:95]
    v_cndmask_b32 v151, v135, v151, s[78:79]
    buffer_load_dwordx4 a[20:23], v50, s[32:35], s101 offen offset:1024 sc1
    v_cndmask_b32 v152, v136, v152, s[80:81]
    v_cndmask_b32 v153, v137, v153, s[82:83]
    v_cndmask_b32 v154, v138, v154, s[84:85]
    buffer_load_dwordx4 a[24:27], v50, s[32:35], s101 offen offset:2048 sc1
    v_cndmask_b32 v155, v139, v155, s[86:87]
    v_cndmask_b32 v156, v140, v156, s[88:89]
    v_mfma_f32_32x32x16_bf16 v[80:95], a[168:171], v[176:179], v[80:95]
    v_cndmask_b32 v157, v141, v157, s[90:91]
    v_cndmask_b32 v158, v142, v158, s[92:93]
    buffer_load_dwordx4 a[28:31], v50, s[32:35], s101 offen offset:3072 sc1
    v_cndmask_b32 v159, v143, v159, s[94:95]
    v_exp_f32 v144, v144
    v_exp_f32 v145, v145
    s_add_u32 m0, s52, 114688
    v_exp_f32 v146, v146
    v_mfma_f32_32x32x16_bf16 v[80:95], a[172:175], v[180:183], v[80:95]
    v_exp_f32 v147, v147
    v_exp_f32 v148, v148
    v_exp_f32 v149, v149
    s_xor_b32 s100, s100, 98304
    v_exp_f32 v150, v150
    v_exp_f32 v151, v151
    buffer_load_dwordx4 v8, s[20:23], s100 offen offset:0 lds
    v_cvt_pk_bf16_f32 v168, v144, v145
    v_mfma_f32_32x32x16_bf16 v[112:127], a[160:163], v[60:63], 0
    v_cvt_pk_bf16_f32 v169, v146, v147
    v_exp_f32 v152, v152
    v_exp_f32 v153, v153
    buffer_load_dwordx4 v9, s[20:23], s100 offen offset:1024 lds
    v_exp_f32 v154, v154
    v_exp_f32 v155, v155
    v_cvt_pk_bf16_f32 v170, v148, v149
    buffer_load_dwordx4 v10, s[20:23], s100 offen offset:2048 lds
    v_cvt_pk_bf16_f32 v171, v150, v151
    v_exp_f32 v156, v156
    v_exp_f32 v157, v157
    buffer_load_dwordx4 v11, s[20:23], s100 offen offset:3072 lds
    v_exp_f32 v158, v158
    v_exp_f32 v159, v159
    v_cvt_pk_bf16_f32 v172, v152, v153
    s_cmp_eq_u32 s1, 1020
    s_cbranch_scc1 L_epoch_9
L_noepoch_10:
    v_cvt_pk_bf16_f32 v173, v154, v155
    v_cvt_pk_bf16_f32 v174, v156, v157
    v_cvt_pk_bf16_f32 v175, v158, v159
    v_and_b32 v176, v168, v72
    v_and_b32 v168, v168, v64
    v_and_b32 v177, v169, v73
    v_and_b32 v169, v169, v65
    v_and_b32 v178, v170, v74
    v_and_b32 v170, v170, v66
    v_and_b32 v179, v171, v75
    v_and_b32 v171, v171, v67
    v_and_b32 v180, v172, v76
    v_and_b32 v172, v172, v68
    v_and_b32 v181, v173, v77
    v_and_b32 v173, v173, v69
    v_and_b32 v182, v174, v78
    v_and_b32 v174, v174, v70
    v_and_b32 v183, v175, v79
    v_and_b32 v175, v175, v71
    v_exp_f32 v112, v112
    v_mfma_f32_32x32x16_bf16 v[128:143], a[156:159], v[56:59], 0
    v_exp_f32 v113, v113
    s_xor_b32 s101, s101, 12288
    v_exp_f32 v114, v114
    v_exp_f32 v115, v115
    buffer_load_dwordx4 a[32:35], v50, s[32:35], s101 offen offset:0 sc1
    v_exp_f32 v116, v116
    v_exp_f32 v117, v117
    v_mfma_f32_32x32x16_bf16 v[96:111], a[240:243], v[168:171], 0
    v_exp_f32 v118, v118
    v_exp_f32 v119, v119
    buffer_load_dwordx4 a[36:39], v50, s[32:35], s101 offen offset:1024 sc1
    v_cvt_pk_bf16_f32 v160, v112, v113
    v_cvt_pk_bf16_f32 v161, v114, v115
    buffer_load_dwordx4 a[40:43], v50, s[32:35], s101 offen offset:2048 sc1
    v_exp_f32 v120, v120
    v_mfma_f32_32x32x16_bf16 v[96:111], a[244:247], v[172:175], v[96:111]
    v_exp_f32 v121, v121
    v_exp_f32 v122, v122
    v_exp_f32 v123, v123
    buffer_load_dwordx4 a[44:47], v50, s[32:35], s101 offen offset:3072 sc1
    v_cvt_pk_bf16_f32 v162, v116, v117
    v_cvt_pk_bf16_f32 v163, v118, v119
    v_mfma_f32_32x32x16_bf16 v[96:111], a[176:179], v[176:179], v[96:111]
    v_exp_f32 v124, v124
    s_waitcnt vmcnt(16)
    v_exp_f32 v125, v125
    v_exp_f32 v126, v126
    v_exp_f32 v127, v127
    s_mov_b32 s56, 65536
    s_mov_b64 exec, 1
    buffer_store_dword v2, v3, s[32:35], s56 offen sc1
    s_mov_b64 exec, -1
    v_cvt_pk_bf16_f32 v164, v120, v121
    v_mfma_f32_32x32x16_bf16 v[96:111], a[180:183], v[180:183], v[96:111]
    v_cvt_pk_bf16_f32 v165, v122, v123
    v_cvt_pk_bf16_f32 v166, v124, v125
    v_cvt_pk_bf16_f32 v167, v126, v127
    v_exp_f32 v128, v128
    v_mfma_f32_32x32x16_bf16 v[112:127], a[156:159], v[60:63], 0
    v_exp_f32 v129, v129
    s_xor_b32 s101, s101, 4096
    v_exp_f32 v130, v130
    v_exp_f32 v131, v131
    v_exp_f32 v132, v132
    v_exp_f32 v133, v133
    buffer_load_dwordx4 a[48:51], v50, s[32:35], s101 offen offset:0 sc1
    v_exp_f32 v134, v134
    v_exp_f32 v135, v135
    v_mfma_f32_32x32x16_bf16 v[96:111], a[232:235], v[160:163], v[96:111]
    v_cvt_pk_bf16_f32 v168, v128, v129
    v_cvt_pk_bf16_f32 v169, v130, v131
    v_exp_f32 v136, v136
    buffer_load_dwordx4 a[52:55], v50, s[32:35], s101 offen offset:1024 sc1
    v_exp_f32 v137, v137
    v_exp_f32 v138, v138
    v_exp_f32 v139, v139
    v_cvt_pk_bf16_f32 v170, v132, v133
    v_mfma_f32_32x32x16_bf16 v[96:111], a[236:239], v[164:167], v[96:111]
    v_cvt_pk_bf16_f32 v171, v134, v135
    buffer_load_dwordx4 a[56:59], v50, s[32:35], s101 offen offset:2048 sc1
    v_exp_f32 v140, v140
    v_exp_f32 v141, v141
    v_exp_f32 v142, v142
    v_exp_f32 v143, v143
    buffer_load_dwordx4 a[60:63], v50, s[32:35], s101 offen offset:3072 sc1
    v_cvt_pk_bf16_f32 v172, v136, v137
    v_cvt_pk_bf16_f32 v173, v138, v139
    v_cvt_pk_bf16_f32 v174, v140, v141
    v_cvt_pk_bf16_f32 v175, v142, v143
    v_exp_f32 v112, v112
    v_mfma_f32_32x32x16_bf16 v[128:143], a[152:155], v[56:59], 0
    v_exp_f32 v113, v113
    s_add_u32 m0, s52, 0
    v_exp_f32 v114, v114
    v_exp_f32 v115, v115
    v_exp_f32 v116, v116
    s_xor_b32 s100, s100, 32768
    v_exp_f32 v117, v117
    v_exp_f32 v118, v118
    v_exp_f32 v119, v119
    v_mfma_f32_32x32x16_bf16 v[80:95], a[224:227], v[168:171], v[80:95]
    v_cvt_pk_bf16_f32 v160, v112, v113
    buffer_load_dwordx4 v8, s[20:23], s100 offen offset:0 lds
    v_cvt_pk_bf16_f32 v161, v114, v115
    v_exp_f32 v120, v120
    v_exp_f32 v121, v121
    v_exp_f32 v122, v122
    buffer_load_dwordx4 v9, s[20:23], s100 offen offset:1024 lds
    v_exp_f32 v123, v123
    v_cvt_pk_bf16_f32 v162, v116, v117
    v_mfma_f32_32x32x16_bf16 v[80:95], a[228:231], v[172:175], v[80:95]
    v_cvt_pk_bf16_f32 v163, v118, v119
    v_exp_f32 v124, v124
    buffer_load_dwordx4 v10, s[20:23], s100 offen offset:2048 lds
    v_exp_f32 v125, v125
    v_exp_f32 v126, v126
    v_exp_f32 v127, v127
    buffer_load_dwordx4 v11, s[20:23], s100 offen offset:3072 lds
    v_cvt_pk_bf16_f32 v164, v120, v121
    v_cvt_pk_bf16_f32 v165, v122, v123
    v_cvt_pk_bf16_f32 v166, v124, v125
    v_cvt_pk_bf16_f32 v167, v126, v127
    v_exp_f32 v128, v128
    v_mfma_f32_32x32x16_bf16 v[112:127], a[152:155], v[60:63], 0
    v_exp_f32 v129, v129
    s_xor_b32 s101, s101, 28672
    v_exp_f32 v130, v130
    v_exp_f32 v131, v131
    v_exp_f32 v132, v132
    buffer_load_dwordx4 a[64:67], v50, s[32:35], s101 offen offset:0 sc1
    v_exp_f32 v133, v133
    v_exp_f32 v134, v134
    v_exp_f32 v135, v135
    v_mfma_f32_32x32x16_bf16 v[96:111], a[224:227], v[160:163], v[96:111]
    v_cvt_pk_bf16_f32 v168, v128, v129
    buffer_load_dwordx4 a[68:71], v50, s[32:35], s101 offen offset:1024 sc1
    v_cvt_pk_bf16_f32 v169, v130, v131
    v_exp_f32 v136, v136
    v_exp_f32 v137, v137
    v_exp_f32 v138, v138
    buffer_load_dwordx4 a[72:75], v50, s[32:35], s101 offen offset:2048 sc1
    v_exp_f32 v139, v139
    v_cvt_pk_bf16_f32 v170, v132, v133
    v_mfma_f32_32x32x16_bf16 v[96:111], a[228:231], v[164:167], v[96:111]
    v_cvt_pk_bf16_f32 v171, v134, v135
    v_exp_f32 v140, v140
    buffer_load_dwordx4 a[76:79], v50, s[32:35], s101 offen offset:3072 sc1
    v_exp_f32 v141, v141
    v_exp_f32 v142, v142
    v_exp_f32 v143, v143
    s_add_u32 m0, s52, 16384
    v_cvt_pk_bf16_f32 v172, v136, v137
    v_cvt_pk_bf16_f32 v173, v138, v139
    v_cvt_pk_bf16_f32 v174, v140, v141
    v_cvt_pk_bf16_f32 v175, v142, v143
    v_exp_f32 v112, v112
    v_mfma_f32_32x32x16_bf16 v[128:143], a[148:151], v[56:59], 0
    v_exp_f32 v113, v113
    s_xor_b32 s100, s47, 0
    v_exp_f32 v114, v114
    v_exp_f32 v115, v115
    s_add_u32 s100, s100, s48
    v_exp_f32 v116, v116
    v_exp_f32 v117, v117
    v_exp_f32 v118, v118
    s_lshl_b32 s100, s100, 15
    v_exp_f32 v119, v119
    v_mfma_f32_32x32x16_bf16 v[80:95], a[216:219], v[168:171], v[80:95]
    v_cvt_pk_bf16_f32 v160, v112, v113
    v_cvt_pk_bf16_f32 v161, v114, v115
    v_exp_f32 v120, v120
    buffer_load_dwordx4 v8, s[20:23], s100 offen offset:0 lds
    v_exp_f32 v121, v121
    v_exp_f32 v122, v122
    v_exp_f32 v123, v123
    buffer_load_dwordx4 v9, s[20:23], s100 offen offset:1024 lds
    v_cvt_pk_bf16_f32 v162, v116, v117
    v_mfma_f32_32x32x16_bf16 v[80:95], a[220:223], v[172:175], v[80:95]
    v_cvt_pk_bf16_f32 v163, v118, v119
    v_exp_f32 v124, v124
    v_exp_f32 v125, v125
    buffer_load_dwordx4 v10, s[20:23], s100 offen offset:2048 lds
    v_exp_f32 v126, v126
    v_exp_f32 v127, v127
    v_cvt_pk_bf16_f32 v164, v120, v121
    buffer_load_dwordx4 v11, s[20:23], s100 offen offset:3072 lds
    v_cvt_pk_bf16_f32 v165, v122, v123
    v_cvt_pk_bf16_f32 v166, v124, v125
    v_cvt_pk_bf16_f32 v167, v126, v127
    v_exp_f32 v128, v128
    v_mfma_f32_32x32x16_bf16 v[112:127], a[148:151], v[60:63], 0
    v_exp_f32 v129, v129
    s_xor_b32 s101, s101, 4096
    v_exp_f32 v130, v130
    v_exp_f32 v131, v131
    v_exp_f32 v132, v132
    buffer_load_dwordx4 a[80:83], v50, s[32:35], s101 offen offset:0 sc1
    v_exp_f32 v133, v133
    v_exp_f32 v134, v134
    v_exp_f32 v135, v135
    v_mfma_f32_32x32x16_bf16 v[96:111], a[216:219], v[160:163], v[96:111]
    v_cvt_pk_bf16_f32 v168, v128, v129
    buffer_load_dwordx4 a[84:87], v50, s[32:35], s101 offen offset:1024 sc1
    v_cvt_pk_bf16_f32 v169, v130, v131
    v_exp_f32 v136, v136
    v_exp_f32 v137, v137
    v_exp_f32 v138, v138
    buffer_load_dwordx4 a[88:91], v50, s[32:35], s101 offen offset:2048 sc1
    v_exp_f32 v139, v139
    v_cvt_pk_bf16_f32 v170, v132, v133
    v_mfma_f32_32x32x16_bf16 v[96:111], a[220:223], v[164:167], v[96:111]
    v_cvt_pk_bf16_f32 v171, v134, v135
    v_exp_f32 v140, v140
    buffer_load_dwordx4 a[92:95], v50, s[32:35], s101 offen offset:3072 sc1
    v_exp_f32 v141, v141
    v_exp_f32 v142, v142
    v_exp_f32 v143, v143
    s_add_u32 m0, s52, 32768
    v_cvt_pk_bf16_f32 v172, v136, v137
    v_cvt_pk_bf16_f32 v173, v138, v139
    v_cvt_pk_bf16_f32 v174, v140, v141
    v_cvt_pk_bf16_f32 v175, v142, v143
    v_exp_f32 v112, v112
    v_mfma_f32_32x32x16_bf16 v[128:143], a[144:147], v[56:59], 0
    v_exp_f32 v113, v113
    s_xor_b32 s100, s47, 1
    v_exp_f32 v114, v114
    v_exp_f32 v115, v115
    s_add_u32 s100, s100, s48
    v_exp_f32 v116, v116
    v_exp_f32 v117, v117
    v_exp_f32 v118, v118
    s_lshl_b32 s100, s100, 15
    v_exp_f32 v119, v119
    v_mfma_f32_32x32x16_bf16 v[80:95], a[208:211], v[168:171], v[80:95]
    v_cvt_pk_bf16_f32 v160, v112, v113
    v_cvt_pk_bf16_f32 v161, v114, v115
    v_exp_f32 v120, v120
    buffer_load_dwordx4 v8, s[20:23], s100 offen offset:0 lds
    v_exp_f32 v121, v121
    v_exp_f32 v122, v122
    v_exp_f32 v123, v123
    buffer_load_dwordx4 v9, s[20:23], s100 offen offset:1024 lds
    v_cvt_pk_bf16_f32 v162, v116, v117
    v_mfma_f32_32x32x16_bf16 v[80:95], a[212:215], v[172:175], v[80:95]
    v_cvt_pk_bf16_f32 v163, v118, v119
    v_exp_f32 v124, v124
    v_exp_f32 v125, v125
    buffer_load_dwordx4 v10, s[20:23], s100 offen offset:2048 lds
    v_exp_f32 v126, v126
    v_exp_f32 v127, v127
    v_cvt_pk_bf16_f32 v164, v120, v121
    buffer_load_dwordx4 v11, s[20:23], s100 offen offset:3072 lds
    v_cvt_pk_bf16_f32 v165, v122, v123
    v_cvt_pk_bf16_f32 v166, v124, v125
    v_cvt_pk_bf16_f32 v167, v126, v127
    v_exp_f32 v128, v128
    v_mfma_f32_32x32x16_bf16 v[112:127], a[144:147], v[60:63], 0
    v_exp_f32 v129, v129
    s_cmp_eq_u32 s1, 1020
    s_cbranch_scc1 L_epoch_12
L_noepoch_13:
    v_exp_f32 v130, v130
    v_exp_f32 v131, v131
    v_exp_f32 v132, v132
    v_exp_f32 v133, v133
    s_xor_b32 s101, s101, 12288
    v_exp_f32 v134, v134
    v_exp_f32 v135, v135
    v_mfma_f32_32x32x16_bf16 v[96:111], a[208:211], v[160:163], v[96:111]
    v_cvt_pk_bf16_f32 v168, v128, v129
    v_cvt_pk_bf16_f32 v169, v130, v131
    v_exp_f32 v136, v136
    buffer_load_dwordx4 a[96:99], v50, s[32:35], s101 offen offset:0 sc1
    v_exp_f32 v137, v137
    v_exp_f32 v138, v138
    v_exp_f32 v139, v139
    v_cvt_pk_bf16_f32 v170, v132, v133
    v_mfma_f32_32x32x16_bf16 v[96:111], a[212:215], v[164:167], v[96:111]
    v_cvt_pk_bf16_f32 v171, v134, v135
    buffer_load_dwordx4 a[100:103], v50, s[32:35], s101 offen offset:1024 sc1
    v_exp_f32 v140, v140
    v_exp_f32 v141, v141
    v_exp_f32 v142, v142
    v_exp_f32 v143, v143
    buffer_load_dwordx4 a[104:107], v50, s[32:35], s101 offen offset:2048 sc1
    v_cvt_pk_bf16_f32 v172, v136, v137
    v_cvt_pk_bf16_f32 v173, v138, v139
    v_cvt_pk_bf16_f32 v174, v140, v141
    v_cvt_pk_bf16_f32 v175, v142, v143
    v_exp_f32 v112, v112
    v_mfma_f32_32x32x16_bf16 v[128:143], a[140:143], v[56:59], 0
    v_exp_f32 v113, v113
    buffer_load_dwordx4 a[108:111], v50, s[32:35], s101 offen offset:3072 sc1
    v_exp_f32 v114, v114
    v_exp_f32 v115, v115
    v_exp_f32 v116, v116
    s_xor_b32 s101, s101, 4096
    v_exp_f32 v117, v117
    v_exp_f32 v118, v118
    v_exp_f32 v119, v119
    v_mfma_f32_32x32x16_bf16 v[80:95], a[200:203], v[168:171], v[80:95]
    v_cvt_pk_bf16_f32 v160, v112, v113
    buffer_load_dwordx4 a[112:115], v50, s[32:35], s101 offen offset:0 sc1
    v_cvt_pk_bf16_f32 v161, v114, v115
    v_exp_f32 v120, v120
    v_exp_f32 v121, v121
    v_exp_f32 v122, v122
    buffer_load_dwordx4 a[116:119], v50, s[32:35], s101 offen offset:1024 sc1
    v_exp_f32 v123, v123
    v_cvt_pk_bf16_f32 v162, v116, v117
    v_mfma_f32_32x32x16_bf16 v[80:95], a[204:207], v[172:175], v[80:95]
    v_cvt_pk_bf16_f32 v163, v118, v119
    v_exp_f32 v124, v124
    buffer_load_dwordx4 a[120:123], v50, s[32:35], s101 offen offset:2048 sc1
    v_exp_f32 v125, v125
    v_exp_f32 v126, v126
    v_exp_f32 v127, v127
    buffer_load_dwordx4 a[124:127], v50, s[32:35], s101 offen offset:3072 sc1
    v_cvt_pk_bf16_f32 v164, v120, v121
    v_cvt_pk_bf16_f32 v165, v122, v123
    v_cvt_pk_bf16_f32 v166, v124, v125
    v_cvt_pk_bf16_f32 v167, v126, v127
    v_exp_f32 v128, v128
    v_mfma_f32_32x32x16_bf16 v[112:127], a[140:143], v[60:63], 0
    v_exp_f32 v129, v129
    s_mov_b32 s56, 32768
    buffer_load_dword v7, v6, s[32:35], s56 offen sc1
    v_exp_f32 v130, v130
    v_exp_f32 v131, v131
    v_exp_f32 v132, v132
    v_exp_f32 v133, v133
    v_exp_f32 v134, v134
    ds_read_b64_tr_b16 v[192:193], v18 offset:0
    ds_read_b64_tr_b16 v[194:195], v18 offset:2048
    ds_read_b64_tr_b16 v[208:209], v18 offset:16384
    ds_read_b64_tr_b16 v[210:211], v18 offset:18432
    v_exp_f32 v135, v135
    v_mfma_f32_32x32x16_bf16 v[96:111], a[200:203], v[160:163], v[96:111]
    v_cvt_pk_bf16_f32 v168, v128, v129
    v_cvt_pk_bf16_f32 v169, v130, v131
    v_exp_f32 v136, v136
    v_exp_f32 v137, v137
    v_exp_f32 v138, v138
    ds_read_b64_tr_b16 v[196:197], v19 offset:0
    ds_read_b64_tr_b16 v[198:199], v19 offset:2048
    ds_read_b64_tr_b16 v[212:213], v19 offset:16384
    ds_read_b64_tr_b16 v[214:215], v19 offset:18432
    v_exp_f32 v139, v139
    v_cvt_pk_bf16_f32 v170, v132, v133
    v_mfma_f32_32x32x16_bf16 v[96:111], a[204:207], v[164:167], v[96:111]
    v_cvt_pk_bf16_f32 v171, v134, v135
    v_exp_f32 v140, v140
    v_exp_f32 v141, v141
    v_exp_f32 v142, v142
    ds_read_b64_tr_b16 v[200:201], v20 offset:0
    ds_read_b64_tr_b16 v[202:203], v20 offset:2048
    ds_read_b64_tr_b16 v[216:217], v20 offset:16384
    ds_read_b64_tr_b16 v[218:219], v20 offset:18432
    v_exp_f32 v143, v143
    v_cvt_pk_bf16_f32 v172, v136, v137
    v_cvt_pk_bf16_f32 v173, v138, v139
    v_cvt_pk_bf16_f32 v174, v140, v141
    v_cvt_pk_bf16_f32 v175, v142, v143
    v_exp_f32 v112, v112
    v_mfma_f32_32x32x16_bf16 v[128:143], a[136:139], v[56:59], 0
    v_exp_f32 v113, v113
    ds_read_b64_tr_b16 v[204:205], v21 offset:0
    ds_read_b64_tr_b16 v[206:207], v21 offset:2048
    ds_read_b64_tr_b16 v[220:221], v21 offset:16384
    ds_read_b64_tr_b16 v[222:223], v21 offset:18432
    v_exp_f32 v114, v114
    v_exp_f32 v115, v115
    v_exp_f32 v116, v116
    v_exp_f32 v117, v117
    ds_read_b64_tr_b16 v[224:225], v42 offset:49152
    ds_read_b64_tr_b16 v[226:227], v42 offset:51200
    ds_read_b64_tr_b16 v[240:241], v14 offset:0
    ds_read_b64_tr_b16 v[242:243], v14 offset:2048
    v_exp_f32 v118, v118
    v_exp_f32 v119, v119
    v_mfma_f32_32x32x16_bf16 v[80:95], a[192:195], v[168:171], v[80:95]
    v_cvt_pk_bf16_f32 v160, v112, v113
    v_cvt_pk_bf16_f32 v161, v114, v115
    v_exp_f32 v120, v120
    ds_read_b64_tr_b16 v[228:229], v43 offset:49152
    ds_read_b64_tr_b16 v[230:231], v43 offset:51200
    ds_read_b64_tr_b16 v[244:245], v15 offset:0
    ds_read_b64_tr_b16 v[246:247], v15 offset:2048
    v_exp_f32 v121, v121
    v_exp_f32 v122, v122
    v_exp_f32 v123, v123
    v_cvt_pk_bf16_f32 v162, v116, v117
    v_mfma_f32_32x32x16_bf16 v[80:95], a[196:199], v[172:175], v[80:95]
    v_cvt_pk_bf16_f32 v163, v118, v119
    ds_read_b64_tr_b16 v[232:233], v44 offset:49152
    ds_read_b64_tr_b16 v[234:235], v44 offset:51200
    ds_read_b64_tr_b16 v[248:249], v16 offset:0
    ds_read_b64_tr_b16 v[250:251], v16 offset:2048
    v_exp_f32 v124, v124
    v_exp_f32 v125, v125
    v_exp_f32 v126, v126
    v_exp_f32 v127, v127
    ds_read_b64_tr_b16 v[236:237], v45 offset:49152
    ds_read_b64_tr_b16 v[238:239], v45 offset:51200
    ds_read_b64_tr_b16 v[252:253], v17 offset:0
    ds_read_b64_tr_b16 v[254:255], v17 offset:2048
    v_cvt_pk_bf16_f32 v164, v120, v121
    v_cvt_pk_bf16_f32 v165, v122, v123
    v_cvt_pk_bf16_f32 v166, v124, v125
    v_cvt_pk_bf16_f32 v167, v126, v127
    v_exp_f32 v128, v128
    v_mfma_f32_32x32x16_bf16 v[112:127], a[136:139], v[60:63], 0
    v_exp_f32 v129, v129
    s_waitcnt lgkmcnt(0)
    v_exp_f32 v130, v130
    v_exp_f32 v131, v131
    s_add_u32 m0, s52, 131072
    v_exp_f32 v132, v132
    v_exp_f32 v133, v133
    v_exp_f32 v134, v134
    s_xor_b32 s100, s47, 2
    v_exp_f32 v135, v135
    v_mfma_f32_32x32x16_bf16 v[96:111], a[192:195], v[160:163], v[96:111]
    v_cvt_pk_bf16_f32 v168, v128, v129
    v_cvt_pk_bf16_f32 v169, v130, v131
    s_add_u32 s100, s100, s48
    v_exp_f32 v136, v136
    v_exp_f32 v137, v137
    v_exp_f32 v138, v138
    s_lshl_b32 s100, s100, 15
    v_exp_f32 v139, v139
    v_cvt_pk_bf16_f32 v170, v132, v133
    v_mfma_f32_32x32x16_bf16 v[96:111], a[196:199], v[164:167], v[96:111]
    v_cvt_pk_bf16_f32 v171, v134, v135
    buffer_load_dwordx4 v8, s[20:23], s100 offen offset:0 lds
    v_exp_f32 v140, v140
    v_exp_f32 v141, v141
    v_exp_f32 v142, v142
    buffer_load_dwordx4 v9, s[20:23], s100 offen offset:1024 lds
    v_exp_f32 v143, v143
    v_cvt_pk_bf16_f32 v172, v136, v137
    buffer_load_dwordx4 v10, s[20:23], s100 offen offset:2048 lds
    v_cvt_pk_bf16_f32 v173, v138, v139
    v_cvt_pk_bf16_f32 v174, v140, v141
    v_cvt_pk_bf16_f32 v175, v142, v143
    v_exp_f32 v112, v112
    v_mfma_f32_32x32x16_bf16 v[128:143], a[132:135], v[56:59], 0
    v_exp_f32 v113, v113
    buffer_load_dwordx4 v11, s[20:23], s100 offen offset:3072 lds
    v_exp_f32 v114, v114
    v_exp_f32 v115, v115
    s_add_u32 m0, s52, 147456
    v_exp_f32 v116, v116
    v_exp_f32 v117, v117
    s_xor_b32 s100, s47, 3
    v_exp_f32 v118, v118
    v_exp_f32 v119, v119
    v_mfma_f32_32x32x16_bf16 v[80:95], a[184:187], v[168:171], v[80:95]
    v_cvt_pk_bf16_f32 v160, v112, v113
    s_add_u32 s100, s100, s48
    v_cvt_pk_bf16_f32 v161, v114, v115
    v_exp_f32 v120, v120
    s_lshl_b32 s100, s100, 15
    v_exp_f32 v121, v121
    v_exp_f32 v122, v122
    v_exp_f32 v123, v123
    buffer_load_dwordx4 v8, s[20:23], s100 offen offset:0 lds
    v_cvt_pk_bf16_f32 v162, v116, v117
    v_mfma_f32_32x32x16_bf16 v[80:95], a[188:191], v[172:175], v[80:95]
    v_cvt_pk_bf16_f32 v163, v118, v119
    v_exp_f32 v124, v124
    buffer_load_dwordx4 v9, s[20:23], s100 offen offset:1024 lds
    v_exp_f32 v125, v125
    v_exp_f32 v126, v126
    buffer_load_dwordx4 v10, s[20:23], s100 offen offset:2048 lds
    v_exp_f32 v127, v127
    v_cvt_pk_bf16_f32 v164, v120, v121
    buffer_load_dwordx4 v11, s[20:23], s100 offen offset:3072 lds
    v_cvt_pk_bf16_f32 v165, v122, v123
    v_cvt_pk_bf16_f32 v166, v124, v125
    v_cvt_pk_bf16_f32 v167, v126, v127
    v_exp_f32 v128, v128
    v_mfma_f32_32x32x16_bf16 v[96:111], a[184:187], v[160:163], v[96:111]
    v_exp_f32 v129, v129
    s_add_u32 m0, s52, 49152
    v_exp_f32 v130, v130
    v_exp_f32 v131, v131
    s_and_b32 s100, s47, 1
    v_exp_f32 v132, v132
    v_exp_f32 v133, v133
    s_xor_b32 s100, s100, 4
    v_exp_f32 v134, v134
    v_exp_f32 v135, v135
    v_mfma_f32_32x32x16_bf16 v[96:111], a[188:191], v[164:167], v[96:111]
    v_cvt_pk_bf16_f32 v168, v128, v129
    v_cvt_pk_bf16_f32 v169, v130, v131
    s_add_u32 s100, s100, s48
    v_exp_f32 v136, v136
    v_exp_f32 v137, v137
    s_lshl_b32 s100, s100, 15
    v_exp_f32 v138, v138
    v_exp_f32 v139, v139
    buffer_load_dwordx4 v8, s[20:23], s100 offen offset:0 lds
    v_cvt_pk_bf16_f32 v170, v132, v133
    v_cvt_pk_bf16_f32 v171, v134, v135
    v_exp_f32 v140, v140
    buffer_load_dwordx4 v9, s[20:23], s100 offen offset:1024 lds
    v_exp_f32 v141, v141
    v_exp_f32 v142, v142
    buffer_load_dwordx4 v10, s[20:23], s100 offen offset:2048 lds
    v_exp_f32 v143, v143
    v_cvt_pk_bf16_f32 v172, v136, v137
    buffer_load_dwordx4 v11, s[20:23], s100 offen offset:3072 lds
    v_cvt_pk_bf16_f32 v173, v138, v139
    v_cvt_pk_bf16_f32 v174, v140, v141
    v_cvt_pk_bf16_f32 v175, v142, v143
    v_mfma_f32_32x32x16_bf16 v[80:95], a[176:179], v[168:171], v[80:95]
    s_nop 0
    v_mfma_f32_32x32x16_bf16 v[80:95], a[180:183], v[172:175], v[80:95]
L_attn_done_11:
    s_mov_b32 s53, 0x17800000
    s_mov_b32 s54, 0x71800000
    v_mov_b32 v27, 0x7f000000
    v_add_f32 v23, |v96|, |v97|
    v_add_f32 v23, v23, |v98|
    v_add_f32 v23, v23, |v99|
    v_add_f32 v23, v23, |v100|
    v_add_f32 v23, v23, |v101|
    v_add_f32 v23, v23, |v102|
    v_add_f32 v23, v23, |v103|
    s_nop 1
    v_min_f32 v24, v88, v104
    v_add_f32 v25, v88, v104
    v_add_f32 v23, v23, |v80|
    v_add_f32 v23, v23, |v81|
    v_add_f32 v23, v23, |v82|
    v_add_f32 v23, v23, |v83|
    v_add_f32 v23, v23, |v84|
    v_add_f32 v23, v23, |v85|
    v_add_f32 v23, v23, |v86|
    v_add_f32 v23, v23, |v87|
    v_cmp_le_f32 vcc, s53, v24
    v_cmp_ge_f32 s[4:5], s54, v25
    s_nop 0
    s_and_b64 vcc, vcc, s[4:5]
    v_cmp_lt_f32 s[4:5], v23, v27
    s_nop 0
    s_and_b64 vcc, vcc, s[4:5]
    s_cmp_eq_u64 vcc, -1
    s_cbranch_scc0 L_attn_safe_17
L_attn_ok_16:
    v_rcp_f32 v88, v88
    v_rcp_f32 v104, v104
    v_pk_mul_f32 v[80:81], v[80:81], v[88:89] op_sel_hi:[1,0]
    v_pk_mul_f32 v[82:83], v[82:83], v[88:89] op_sel_hi:[1,0]
    v_pk_mul_f32 v[84:85], v[84:85], v[88:89] op_sel_hi:[1,0]
    v_pk_mul_f32 v[86:87], v[86:87], v[88:89] op_sel_hi:[1,0]
    v_cvt_pk_bf16_f32 v164, v80, v81
    v_cvt_pk_bf16_f32 v165, v82, v83
    v_cvt_pk_bf16_f32 v166, v84, v85
    v_cvt_pk_bf16_f32 v167, v86, v87
    buffer_store_dwordx4 v[164:167], v39, s[32:35], s63 offen offset:0 sc1
    v_pk_mul_f32 v[96:97], v[96:97], v[104:105] op_sel_hi:[1,0]
    v_pk_mul_f32 v[98:99], v[98:99], v[104:105] op_sel_hi:[1,0]
    v_pk_mul_f32 v[100:101], v[100:101], v[104:105] op_sel_hi:[1,0]
    v_pk_mul_f32 v[102:103], v[102:103], v[104:105] op_sel_hi:[1,0]
    v_cvt_pk_bf16_f32 v168, v96, v97
    v_cvt_pk_bf16_f32 v169, v98, v99
    v_cvt_pk_bf16_f32 v170, v100, v101
    v_cvt_pk_bf16_f32 v171, v102, v103
    buffer_store_dwordx4 v[168:171], v39, s[32:35], s63 offen offset:2048 sc1
    s_waitcnt vmcnt(14)
    v_cmp_ne_u32 vcc, s49, v7
    s_nop 0
    s_cbranch_vccnz L_poll_retry_20
L_poll_ok_21:
    v_mfma_f32_16x16x32_bf16 v[64:67], v[192:195], a[0:3], 0
    v_mfma_f32_16x16x32_bf16 v[64:67], v[208:211], a[16:19], v[64:67]
    v_mfma_f32_16x16x32_bf16 v[80:83], v[192:195], a[4:7], 0
    s_xor_b32 s101, s47, 0
    v_mfma_f32_16x16x32_bf16 v[80:83], v[208:211], a[20:23], v[80:83]
    s_add_u32 s101, s101, s48
    s_lshl_b32 s101, s101, 12
    v_mfma_f32_16x16x32_bf16 v[96:99], v[192:195], a[8:11], 0
    buffer_load_dwordx4 a[128:131], v50, s[32:35], s101 offen offset:0 sc1
    v_mfma_f32_16x16x32_bf16 v[96:99], v[208:211], a[24:27], v[96:99]
    v_mfma_f32_16x16x32_bf16 v[112:115], v[192:195], a[12:15], 0
    v_mfma_f32_16x16x32_bf16 v[112:115], v[208:211], a[28:31], v[112:115]
    v_mfma_f32_16x16x32_bf16 v[68:71], v[196:199], a[0:3], 0
    buffer_load_dwordx4 a[132:135], v50, s[32:35], s101 offen offset:1024 sc1
    v_mfma_f32_16x16x32_bf16 v[68:71], v[212:215], a[16:19], v[68:71]
    v_mfma_f32_16x16x32_bf16 v[84:87], v[196:199], a[4:7], 0
    v_mfma_f32_16x16x32_bf16 v[84:87], v[212:215], a[20:23], v[84:87]
    v_mfma_f32_16x16x32_bf16 v[100:103], v[196:199], a[8:11], 0
    buffer_load_dwordx4 a[136:139], v50, s[32:35], s101 offen offset:2048 sc1
    v_mfma_f32_16x16x32_bf16 v[100:103], v[212:215], a[24:27], v[100:103]
    v_mfma_f32_16x16x32_bf16 v[116:119], v[196:199], a[12:15], 0
    v_mfma_f32_16x16x32_bf16 v[116:119], v[212:215], a[28:31], v[116:119]
    buffer_load_dwordx4 a[140:143], v50, s[32:35], s101 offen offset:3072 sc1
    v_mfma_f32_16x16x32_bf16 v[72:75], v[200:203], a[0:3], 0
    v_mfma_f32_16x16x32_bf16 v[72:75], v[216:219], a[16:19], v[72:75]
    s_xor_b32 s101, s47, 1
    v_mfma_f32_16x16x32_bf16 v[88:91], v[200:203], a[4:7], 0
    s_add_u32 s101, s101, s48
    s_lshl_b32 s101, s101, 12
    v_mfma_f32_16x16x32_bf16 v[88:91], v[216:219], a[20:23], v[88:91]
    buffer_load_dwordx4 a[144:147], v50, s[32:35], s101 offen offset:0 sc1
    v_mfma_f32_16x16x32_bf16 v[104:107], v[200:203], a[8:11], 0
    v_mfma_f32_16x16x32_bf16 v[104:107], v[216:219], a[24:27], v[104:107]
    v_mfma_f32_16x16x32_bf16 v[120:123], v[200:203], a[12:15], 0
    buffer_load_dwordx4 a[148:151], v50, s[32:35], s101 offen offset:1024 sc1
    v_mfma_f32_16x16x32_bf16 v[120:123], v[216:219], a[28:31], v[120:123]
    v_mfma_f32_16x16x32_bf16 v[76:79], v[204:207], a[0:3], 0
    v_mfma_f32_16x16x32_bf16 v[76:79], v[220:223], a[16:19], v[76:79]
    v_mfma_f32_16x16x32_bf16 v[92:95], v[204:207], a[4:7], 0
    buffer_load_dwordx4 a[152:155], v50, s[32:35], s101 offen offset:2048 sc1
    v_mfma_f32_16x16x32_bf16 v[92:95], v[220:223], a[20:23], v[92:95]
    v_mfma_f32_16x16x32_bf16 v[108:111], v[204:207], a[8:11], 0
    v_mfma_f32_16x16x32_bf16 v[108:111], v[220:223], a[24:27], v[108:111]
    v_mfma_f32_16x16x32_bf16 v[124:127], v[204:207], a[12:15], 0
    buffer_load_dwordx4 a[156:159], v50, s[32:35], s101 offen offset:3072 sc1
    v_mfma_f32_16x16x32_bf16 v[124:127], v[220:223], a[28:31], v[124:127]
    s_waitcnt vmcnt(8)
    s_mov_b32 s56, 98304
    s_mov_b64 exec, 1
    buffer_store_dword v2, v3, s[32:35], s56 offen sc1
    s_mov_b64 exec, -1
    v_mfma_f32_16x16x32_bf16 v[64:67], v[224:227], a[32:35], v[64:67]
    v_mfma_f32_16x16x32_bf16 v[64:67], v[240:243], a[48:51], v[64:67]
    v_mfma_f32_16x16x32_bf16 v[80:83], v[224:227], a[36:39], v[80:83]
    ds_read_b64_tr_b16 v[192:193], v14 offset:16384
    s_xor_b32 s101, s47, 2
    s_add_u32 s101, s101, s48
    v_mfma_f32_16x16x32_bf16 v[80:83], v[240:243], a[52:55], v[80:83]
    ds_read_b64_tr_b16 v[194:195], v14 offset:18432
    s_lshl_b32 s101, s101, 12
    v_mfma_f32_16x16x32_bf16 v[96:99], v[224:227], a[40:43], v[96:99]
    buffer_load_dwordx4 a[160:163], v50, s[32:35], s101 offen offset:0 sc1
    v_mfma_f32_16x16x32_bf16 v[96:99], v[240:243], a[56:59], v[96:99]
    ds_read_b64_tr_b16 v[208:209], v14 offset:32768
    v_mfma_f32_16x16x32_bf16 v[112:115], v[224:227], a[44:47], v[112:115]
    ds_read_b64_tr_b16 v[210:211], v14 offset:34816
    v_mfma_f32_16x16x32_bf16 v[112:115], v[240:243], a[60:63], v[112:115]
    ds_read_b64_tr_b16 v[196:197], v15 offset:16384
    v_mfma_f32_16x16x32_bf16 v[68:71], v[228:231], a[32:35], v[68:71]
    buffer_load_dwordx4 a[164:167], v50, s[32:35], s101 offen offset:1024 sc1
    v_mfma_f32_16x16x32_bf16 v[68:71], v[244:247], a[48:51], v[68:71]
    ds_read_b64_tr_b16 v[198:199], v15 offset:18432
    v_mfma_f32_16x16x32_bf16 v[84:87], v[228:231], a[36:39], v[84:87]
    ds_read_b64_tr_b16 v[212:213], v15 offset:32768
    v_mfma_f32_16x16x32_bf16 v[84:87], v[244:247], a[52:55], v[84:87]
    ds_read_b64_tr_b16 v[214:215], v15 offset:34816
    v_mfma_f32_16x16x32_bf16 v[100:103], v[228:231], a[40:43], v[100:103]
    buffer_load_dwordx4 a[168:171], v50, s[32:35], s101 offen offset:2048 sc1
    v_mfma_f32_16x16x32_bf16 v[100:103], v[244:247], a[56:59], v[100:103]
    v_mfma_f32_16x16x32_bf16 v[116:119], v[228:231], a[44:47], v[116:119]
    ds_read_b64_tr_b16 v[200:201], v16 offset:16384
    v_mfma_f32_16x16x32_bf16 v[116:119], v[244:247], a[60:63], v[116:119]
    buffer_load_dwordx4 a[172:175], v50, s[32:35], s101 offen offset:3072 sc1
    v_mfma_f32_16x16x32_bf16 v[72:75], v[232:235], a[32:35], v[72:75]
    ds_read_b64_tr_b16 v[202:203], v16 offset:18432
    s_add_u32 m0, s52, 65536
    s_and_b32 s100, s47, 1
    s_xor_b32 s100, s100, 5
    v_mfma_f32_16x16x32_bf16 v[72:75], v[248:251], a[48:51], v[72:75]
    ds_read_b64_tr_b16 v[216:217], v16 offset:32768
    s_add_u32 s100, s100, s48
    v_mfma_f32_16x16x32_bf16 v[88:91], v[232:235], a[36:39], v[88:91]
    ds_read_b64_tr_b16 v[218:219], v16 offset:34816
    s_lshl_b32 s100, s100, 15
    v_mfma_f32_16x16x32_bf16 v[88:91], v[248:251], a[52:55], v[88:91]
    buffer_load_dwordx4 v8, s[20:23], s100 offen offset:0 lds
    v_mfma_f32_16x16x32_bf16 v[104:107], v[232:235], a[40:43], v[104:107]
    ds_read_b64_tr_b16 v[204:205], v17 offset:16384
    v_mfma_f32_16x16x32_bf16 v[104:107], v[248:251], a[56:59], v[104:107]
    ds_read_b64_tr_b16 v[206:207], v17 offset:18432
    v_mfma_f32_16x16x32_bf16 v[120:123], v[232:235], a[44:47], v[120:123]
    buffer_load_dwordx4 v9, s[20:23], s100 offen offset:1024 lds
    v_mfma_f32_16x16x32_bf16 v[120:123], v[248:251], a[60:63], v[120:123]
    ds_read_b64_tr_b16 v[220:221], v17 offset:32768
    v_mfma_f32_16x16x32_bf16 v[76:79], v[236:239], a[32:35], v[76:79]
    ds_read_b64_tr_b16 v[222:223], v17 offset:34816
    v_mfma_f32_16x16x32_bf16 v[76:79], v[252:255], a[48:51], v[76:79]
    v_mfma_f32_16x16x32_bf16 v[92:95], v[236:239], a[36:39], v[92:95]
    buffer_load_dwordx4 v10, s[20:23], s100 offen offset:2048 lds
    v_mfma_f32_16x16x32_bf16 v[92:95], v[252:255], a[52:55], v[92:95]
    v_mfma_f32_16x16x32_bf16 v[108:111], v[236:239], a[40:43], v[108:111]
    v_mfma_f32_16x16x32_bf16 v[108:111], v[252:255], a[56:59], v[108:111]
    v_mfma_f32_16x16x32_bf16 v[124:127], v[236:239], a[44:47], v[124:127]
    buffer_load_dwordx4 v11, s[20:23], s100 offen offset:3072 lds
    v_mfma_f32_16x16x32_bf16 v[124:127], v[252:255], a[60:63], v[124:127]
    s_waitcnt lgkmcnt(2)
    v_mfma_f32_16x16x32_bf16 v[64:67], v[192:195], a[64:67], v[64:67]
    v_mfma_f32_16x16x32_bf16 v[64:67], v[208:211], a[80:83], v[64:67]
    s_waitcnt lgkmcnt(0)
    v_mfma_f32_16x16x32_bf16 v[80:83], v[192:195], a[68:71], v[80:83]
    ds_read_b64_tr_b16 v[224:225], v14 offset:49152
    s_xor_b32 s101, s47, 3
    s_add_u32 s101, s101, s48
    v_mfma_f32_16x16x32_bf16 v[80:83], v[208:211], a[84:87], v[80:83]
    ds_read_b64_tr_b16 v[226:227], v14 offset:51200
    s_lshl_b32 s101, s101, 12
    v_mfma_f32_16x16x32_bf16 v[96:99], v[192:195], a[72:75], v[96:99]
    buffer_load_dwordx4 a[176:179], v50, s[32:35], s101 offen offset:0 sc1
    v_mfma_f32_16x16x32_bf16 v[96:99], v[208:211], a[88:91], v[96:99]
    ds_read_b64_tr_b16 v[240:241], v42 offset:0
    v_mfma_f32_16x16x32_bf16 v[112:115], v[192:195], a[76:79], v[112:115]
    ds_read_b64_tr_b16 v[242:243], v42 offset:2048
    v_mfma_f32_16x16x32_bf16 v[112:115], v[208:211], a[92:95], v[112:115]
    ds_read_b64_tr_b16 v[228:229], v15 offset:49152
    v_mfma_f32_16x16x32_bf16 v[68:71], v[196:199], a[64:67], v[68:71]
    buffer_load_dwordx4 a[180:183], v50, s[32:35], s101 offen offset:1024 sc1
    v_mfma_f32_16x16x32_bf16 v[68:71], v[212:215], a[80:83], v[68:71]
    ds_read_b64_tr_b16 v[230:231], v15 offset:51200
    v_mfma_f32_16x16x32_bf16 v[84:87], v[196:199], a[68:71], v[84:87]
    ds_read_b64_tr_b16 v[244:245], v43 offset:0
    v_mfma_f32_16x16x32_bf16 v[84:87], v[212:215], a[84:87], v[84:87]
    ds_read_b64_tr_b16 v[246:247], v43 offset:2048
    v_mfma_f32_16x16x32_bf16 v[100:103], v[196:199], a[72:75], v[100:103]
    buffer_load_dwordx4 a[184:187], v50, s[32:35], s101 offen offset:2048 sc1
    v_mfma_f32_16x16x32_bf16 v[100:103], v[212:215], a[88:91], v[100:103]
    v_mfma_f32_16x16x32_bf16 v[116:119], v[196:199], a[76:79], v[116:119]
    ds_read_b64_tr_b16 v[232:233], v16 offset:49152
    v_mfma_f32_16x16x32_bf16 v[116:119], v[212:215], a[92:95], v[116:119]
    buffer_load_dwordx4 a[188:191], v50, s[32:35], s101 offen offset:3072 sc1
    v_mfma_f32_16x16x32_bf16 v[72:75], v[200:203], a[64:67], v[72:75]
    ds_read_b64_tr_b16 v[234:235], v16 offset:51200
    s_and_b32 s101, s47, 1
    s_xor_b32 s101, s101, 4
    v_mfma_f32_16x16x32_bf16 v[72:75], v[216:219], a[80:83], v[72:75]
    ds_read_b64_tr_b16 v[248:249], v44 offset:0
    s_add_u32 s101, s101, s48
    v_mfma_f32_16x16x32_bf16 v[88:91], v[200:203], a[68:71], v[88:91]
    ds_read_b64_tr_b16 v[250:251], v44 offset:2048
    s_lshl_b32 s101, s101, 12
    v_mfma_f32_16x16x32_bf16 v[88:91], v[216:219], a[84:87], v[88:91]
    buffer_load_dwordx4 a[192:195], v50, s[32:35], s101 offen offset:0 sc1
    v_mfma_f32_16x16x32_bf16 v[104:107], v[200:203], a[72:75], v[104:107]
    ds_read_b64_tr_b16 v[236:237], v17 offset:49152
    v_mfma_f32_16x16x32_bf16 v[104:107], v[216:219], a[88:91], v[104:107]
    ds_read_b64_tr_b16 v[238:239], v17 offset:51200
    v_mfma_f32_16x16x32_bf16 v[120:123], v[200:203], a[76:79], v[120:123]
    buffer_load_dwordx4 a[196:199], v50, s[32:35], s101 offen offset:1024 sc1
    v_mfma_f32_16x16x32_bf16 v[120:123], v[216:219], a[92:95], v[120:123]
    ds_read_b64_tr_b16 v[252:253], v45 offset:0
    v_mfma_f32_16x16x32_bf16 v[76:79], v[204:207], a[64:67], v[76:79]
    ds_read_b64_tr_b16 v[254:255], v45 offset:2048
    v_mfma_f32_16x16x32_bf16 v[76:79], v[220:223], a[80:83], v[76:79]
    v_mfma_f32_16x16x32_bf16 v[92:95], v[204:207], a[68:71], v[92:95]
    buffer_load_dwordx4 a[200:203], v50, s[32:35], s101 offen offset:2048 sc1
    v_mfma_f32_16x16x32_bf16 v[92:95], v[220:223], a[84:87], v[92:95]
    v_mfma_f32_16x16x32_bf16 v[108:111], v[204:207], a[72:75], v[108:111]
    v_mfma_f32_16x16x32_bf16 v[108:111], v[220:223], a[88:91], v[108:111]
    v_mfma_f32_16x16x32_bf16 v[124:127], v[204:207], a[76:79], v[124:127]
    buffer_load_dwordx4 a[204:207], v50, s[32:35], s101 offen offset:3072 sc1
    v_mfma_f32_16x16x32_bf16 v[124:127], v[220:223], a[92:95], v[124:127]
    s_waitcnt lgkmcnt(2)
    v_mfma_f32_16x16x32_bf16 v[64:67], v[224:227], a[96:99], v[64:67]
    v_mfma_f32_16x16x32_bf16 v[64:67], v[240:243], a[112:115], v[64:67]
    s_waitcnt lgkmcnt(0)
    v_mfma_f32_16x16x32_bf16 v[80:83], v[224:227], a[100:103], v[80:83]
    ds_read_b64_tr_b16 v[192:193], v42 offset:16384
    s_and_b32 s101, s47, 1
    s_xor_b32 s101, s101, 5
    s_add_u32 s101, s101, s48
    v_mfma_f32_16x16x32_bf16 v[80:83], v[240:243], a[116:119], v[80:83]
    ds_read_b64_tr_b16 v[194:195], v42 offset:18432
    s_lshl_b32 s101, s101, 12
    v_mfma_f32_16x16x32_bf16 v[96:99], v[224:227], a[104:107], v[96:99]
    buffer_load_dwordx4 a[208:211], v50, s[32:35], s101 offen offset:0 sc1
    v_mfma_f32_16x16x32_bf16 v[96:99], v[240:243], a[120:123], v[96:99]
    ds_read_b64_tr_b16 v[208:209], v42 offset:32768
    v_mfma_f32_16x16x32_bf16 v[112:115], v[224:227], a[108:111], v[112:115]
    ds_read_b64_tr_b16 v[210:211], v42 offset:34816
    v_mfma_f32_16x16x32_bf16 v[112:115], v[240:243], a[124:127], v[112:115]
    ds_read_b64_tr_b16 v[196:197], v43 offset:16384
    v_mfma_f32_16x16x32_bf16 v[68:71], v[228:231], a[96:99], v[68:71]
    buffer_load_dwordx4 a[212:215], v50, s[32:35], s101 offen offset:1024 sc1
    v_mfma_f32_16x16x32_bf16 v[68:71], v[244:247], a[112:115], v[68:71]
    ds_read_b64_tr_b16 v[198:199], v43 offset:18432
    v_mfma_f32_16x16x32_bf16 v[84:87], v[228:231], a[100:103], v[84:87]
    ds_read_b64_tr_b16 v[212:213], v43 offset:32768
    v_mfma_f32_16x16x32_bf16 v[84:87], v[244:247], a[116:119], v[84:87]
    ds_read_b64_tr_b16 v[214:215], v43 offset:34816
    v_mfma_f32_16x16x32_bf16 v[100:103], v[228:231], a[104:107], v[100:103]
    buffer_load_dwordx4 a[216:219], v50, s[32:35], s101 offen offset:2048 sc1
    v_mfma_f32_16x16x32_bf16 v[100:103], v[244:247], a[120:123], v[100:103]
    v_mfma_f32_16x16x32_bf16 v[116:119], v[228:231], a[108:111], v[116:119]
    ds_read_b64_tr_b16 v[200:201], v44 offset:16384
    v_mfma_f32_16x16x32_bf16 v[116:119], v[244:247], a[124:127], v[116:119]
    buffer_load_dwordx4 a[220:223], v50, s[32:35], s101 offen offset:3072 sc1
    v_mfma_f32_16x16x32_bf16 v[72:75], v[232:235], a[96:99], v[72:75]
    ds_read_b64_tr_b16 v[202:203], v44 offset:18432
    s_add_u32 m0, s52, 81920
    s_lshl2_add_u32 s100, s44, s47
    s_lshl_b32 s100, s100, 15
    v_add_u32 v9, 15360, v12
    v_mfma_f32_16x16x32_bf16 v[72:75], v[248:251], a[112:115], v[72:75]
    ds_read_b64_tr_b16 v[216:217], v44 offset:32768
    v_add_u32 v10, 6144, v12
    v_mfma_f32_16x16x32_bf16 v[88:91], v[232:235], a[100:103], v[88:91]
    ds_read_b64_tr_b16 v[218:219], v44 offset:34816
    v_add_u32 v11, 21504, v12
    v_mfma_f32_16x16x32_bf16 v[88:91], v[248:251], a[116:119], v[88:91]
    buffer_load_dwordx4 v12, s[24:27], s100 offen offset:0 lds
    v_mfma_f32_16x16x32_bf16 v[104:107], v[232:235], a[104:107], v[104:107]
    ds_read_b64_tr_b16 v[204:205], v45 offset:16384
    v_mfma_f32_16x16x32_bf16 v[104:107], v[248:251], a[120:123], v[104:107]
    ds_read_b64_tr_b16 v[206:207], v45 offset:18432
    v_mfma_f32_16x16x32_bf16 v[120:123], v[232:235], a[108:111], v[120:123]
    buffer_load_dwordx4 v9, s[24:27], s100 offen offset:1024 lds
    v_mfma_f32_16x16x32_bf16 v[120:123], v[248:251], a[124:127], v[120:123]
    ds_read_b64_tr_b16 v[220:221], v45 offset:32768
    v_mfma_f32_16x16x32_bf16 v[76:79], v[236:239], a[96:99], v[76:79]
    ds_read_b64_tr_b16 v[222:223], v45 offset:34816
    v_mfma_f32_16x16x32_bf16 v[76:79], v[252:255], a[112:115], v[76:79]
    v_mfma_f32_16x16x32_bf16 v[92:95], v[236:239], a[100:103], v[92:95]
    buffer_load_dwordx4 v10, s[24:27], s100 offen offset:2048 lds
    v_mfma_f32_16x16x32_bf16 v[92:95], v[252:255], a[116:119], v[92:95]
    v_mfma_f32_16x16x32_bf16 v[108:111], v[236:239], a[104:107], v[108:111]
    v_mfma_f32_16x16x32_bf16 v[108:111], v[252:255], a[120:123], v[108:111]
    v_mfma_f32_16x16x32_bf16 v[124:127], v[236:239], a[108:111], v[124:127]
    buffer_load_dwordx4 v11, s[24:27], s100 offen offset:3072 lds
    v_mfma_f32_16x16x32_bf16 v[124:127], v[252:255], a[124:127], v[124:127]
    s_waitcnt vmcnt(32) lgkmcnt(2)
    v_mfma_f32_16x16x32_bf16 v[64:67], v[192:195], a[128:131], v[64:67]
    s_waitcnt vmcnt(28)
    v_mfma_f32_16x16x32_bf16 v[64:67], v[208:211], a[144:147], v[64:67]
    s_waitcnt lgkmcnt(0)
    v_mfma_f32_16x16x32_bf16 v[80:83], v[192:195], a[132:135], v[80:83]
    ds_read_b64_tr_b16 v[224:225], v18 offset:0
    s_waitcnt vmcnt(27)
    v_mfma_f32_16x16x32_bf16 v[80:83], v[208:211], a[148:151], v[80:83]
    ds_read_b64_tr_b16 v[226:227], v18 offset:2048
    s_add_u32 m0, s52, 98304
    v_mfma_f32_16x16x32_bf16 v[96:99], v[192:195], a[136:139], v[96:99]
    ds_read_b64_tr_b16 v[240:241], v18 offset:16384
    s_xor_b32 s100, s100, 32768
    s_waitcnt vmcnt(26)
    v_mfma_f32_16x16x32_bf16 v[96:99], v[208:211], a[152:155], v[96:99]
    buffer_load_dwordx4 v12, s[24:27], s100 offen offset:0 lds
    v_mfma_f32_16x16x32_bf16 v[112:115], v[192:195], a[140:143], v[112:115]
    ds_read_b64_tr_b16 v[242:243], v18 offset:18432
    s_waitcnt vmcnt(26)
    v_mfma_f32_16x16x32_bf16 v[112:115], v[208:211], a[156:159], v[112:115]
    ds_read_b64_tr_b16 v[228:229], v19 offset:0
    v_mfma_f32_16x16x32_bf16 v[68:71], v[196:199], a[128:131], v[68:71]
    ds_read_b64_tr_b16 v[230:231], v19 offset:2048
    v_mfma_f32_16x16x32_bf16 v[68:71], v[212:215], a[144:147], v[68:71]
    buffer_load_dwordx4 v9, s[24:27], s100 offen offset:1024 lds
    v_mfma_f32_16x16x32_bf16 v[84:87], v[196:199], a[132:135], v[84:87]
    v_mfma_f32_16x16x32_bf16 v[84:87], v[212:215], a[148:151], v[84:87]
    ds_read_b64_tr_b16 v[244:245], v19 offset:16384
    v_mfma_f32_16x16x32_bf16 v[100:103], v[196:199], a[136:139], v[100:103]
    ds_read_b64_tr_b16 v[246:247], v19 offset:18432
    v_mfma_f32_16x16x32_bf16 v[100:103], v[212:215], a[152:155], v[100:103]
    buffer_load_dwordx4 v10, s[24:27], s100 offen offset:2048 lds
    v_mfma_f32_16x16x32_bf16 v[116:119], v[196:199], a[140:143], v[116:119]
    ds_read_b64_tr_b16 v[232:233], v20 offset:0
    v_mfma_f32_16x16x32_bf16 v[116:119], v[212:215], a[156:159], v[116:119]
    ds_read_b64_tr_b16 v[234:235], v20 offset:2048
    v_mfma_f32_16x16x32_bf16 v[72:75], v[200:203], a[128:131], v[72:75]
    ds_read_b64_tr_b16 v[248:249], v20 offset:16384
    v_mfma_f32_16x16x32_bf16 v[72:75], v[216:219], a[144:147], v[72:75]
    buffer_load_dwordx4 v11, s[24:27], s100 offen offset:3072 lds
    v_mfma_f32_16x16x32_bf16 v[88:91], v[200:203], a[132:135], v[88:91]
    v_mfma_f32_16x16x32_bf16 v[88:91], v[216:219], a[148:151], v[88:91]
    ds_read_b64_tr_b16 v[250:251], v20 offset:18432
    v_mfma_f32_16x16x32_bf16 v[104:107], v[200:203], a[136:139], v[104:107]
    ds_read_b64_tr_b16 v[236:237], v21 offset:0
    v_mfma_f32_16x16x32_bf16 v[104:107], v[216:219], a[152:155], v[104:107]
    buffer_load_dwordx4 v[128:131], v40, s[8:11], s3 offen
    v_mfma_f32_16x16x32_bf16 v[120:123], v[200:203], a[140:143], v[120:123]
    ds_read_b64_tr_b16 v[238:239], v21 offset:2048
    v_mfma_f32_16x16x32_bf16 v[120:123], v[216:219], a[156:159], v[120:123]
    ds_read_b64_tr_b16 v[252:253], v21 offset:16384
    v_mfma_f32_16x16x32_bf16 v[76:79], v[204:207], a[128:131], v[76:79]
    ds_read_b64_tr_b16 v[254:255], v21 offset:18432
    s_add_u32 s55, s3, 8192
    v_mfma_f32_16x16x32_bf16 v[76:79], v[220:223], a[144:147], v[76:79]
    buffer_load_dwordx4 v[132:135], v40, s[8:11], s55 offen
    v_mfma_f32_16x16x32_bf16 v[92:95], v[204:207], a[132:135], v[92:95]
    v_mfma_f32_16x16x32_bf16 v[92:95], v[220:223], a[148:151], v[92:95]
    v_mfma_f32_16x16x32_bf16 v[108:111], v[204:207], a[136:139], v[108:111]
    v_mfma_f32_16x16x32_bf16 v[108:111], v[220:223], a[152:155], v[108:111]
    buffer_load_dwordx4 v[136:139], v41, s[40:43], s6 offen
    v_mfma_f32_16x16x32_bf16 v[124:127], v[204:207], a[140:143], v[124:127]
    v_mfma_f32_16x16x32_bf16 v[124:127], v[220:223], a[156:159], v[124:127]
    s_mov_b32 s56, 65536
    buffer_load_dword v7, v6, s[32:35], s56 offen sc1
    s_waitcnt vmcnt(31) lgkmcnt(1)
    v_mfma_f32_16x16x32_bf16 v[64:67], v[224:227], a[160:163], v[64:67]
    s_waitcnt vmcnt(23)
    v_mfma_f32_16x16x32_bf16 v[64:67], v[240:243], a[176:179], v[64:67]
    s_waitcnt lgkmcnt(0)
    v_mfma_f32_16x16x32_bf16 v[80:83], v[224:227], a[164:167], v[80:83]
    ds_read_b64_tr_b16 v[192:193], v42 offset:49152
    s_add_u32 m0, s52, 114688
    s_waitcnt vmcnt(22)
    v_mfma_f32_16x16x32_bf16 v[80:83], v[240:243], a[180:183], v[80:83]
    ds_read_b64_tr_b16 v[194:195], v42 offset:51200
    s_xor_b32 s100, s100, 98304
    v_mfma_f32_16x16x32_bf16 v[96:99], v[224:227], a[168:171], v[96:99]
    buffer_load_dwordx4 v12, s[24:27], s100 offen offset:0 lds
    s_waitcnt vmcnt(22)
    v_mfma_f32_16x16x32_bf16 v[96:99], v[240:243], a[184:187], v[96:99]
    ds_read_b64_tr_b16 v[208:209], v14 offset:0
    v_mfma_f32_16x16x32_bf16 v[112:115], v[224:227], a[172:175], v[112:115]
    ds_read_b64_tr_b16 v[210:211], v14 offset:2048
    s_waitcnt vmcnt(21)
    v_mfma_f32_16x16x32_bf16 v[112:115], v[240:243], a[188:191], v[112:115]
    ds_read_b64_tr_b16 v[196:197], v43 offset:49152
    v_mfma_f32_16x16x32_bf16 v[68:71], v[228:231], a[160:163], v[68:71]
    buffer_load_dwordx4 v9, s[24:27], s100 offen offset:1024 lds
    v_mfma_f32_16x16x32_bf16 v[68:71], v[244:247], a[176:179], v[68:71]
    ds_read_b64_tr_b16 v[198:199], v43 offset:51200
    v_mfma_f32_16x16x32_bf16 v[84:87], v[228:231], a[164:167], v[84:87]
    ds_read_b64_tr_b16 v[212:213], v15 offset:0
    v_mfma_f32_16x16x32_bf16 v[84:87], v[244:247], a[180:183], v[84:87]
    ds_read_b64_tr_b16 v[214:215], v15 offset:2048
    v_mfma_f32_16x16x32_bf16 v[100:103], v[228:231], a[168:171], v[100:103]
    buffer_load_dwordx4 v10, s[24:27], s100 offen offset:2048 lds
    v_mfma_f32_16x16x32_bf16 v[100:103], v[244:247], a[184:187], v[100:103]
    v_mfma_f32_16x16x32_bf16 v[116:119], v[228:231], a[172:175], v[116:119]
    ds_read_b64_tr_b16 v[200:201], v44 offset:49152
    v_mfma_f32_16x16x32_bf16 v[116:119], v[244:247], a[188:191], v[116:119]
    buffer_load_dwordx4 v11, s[24:27], s100 offen offset:3072 lds
    v_mfma_f32_16x16x32_bf16 v[72:75], v[232:235], a[160:163], v[72:75]
    ds_read_b64_tr_b16 v[202:203], v44 offset:51200
    v_mfma_f32_16x16x32_bf16 v[72:75], v[248:251], a[176:179], v[72:75]
    ds_read_b64_tr_b16 v[216:217], v16 offset:0
    s_add_u32 m0, s52, 0
    v_mfma_f32_16x16x32_bf16 v[88:91], v[232:235], a[164:167], v[88:91]
    ds_read_b64_tr_b16 v[218:219], v16 offset:2048
    s_xor_b32 s100, s100, 32768
    v_mfma_f32_16x16x32_bf16 v[88:91], v[248:251], a[180:183], v[88:91]
    buffer_load_dwordx4 v12, s[24:27], s100 offen offset:0 lds
    v_mfma_f32_16x16x32_bf16 v[104:107], v[232:235], a[168:171], v[104:107]
    ds_read_b64_tr_b16 v[204:205], v45 offset:49152
    v_mfma_f32_16x16x32_bf16 v[104:107], v[248:251], a[184:187], v[104:107]
    ds_read_b64_tr_b16 v[206:207], v45 offset:51200
    v_mfma_f32_16x16x32_bf16 v[120:123], v[232:235], a[172:175], v[120:123]
    buffer_load_dwordx4 v9, s[24:27], s100 offen offset:1024 lds
    v_mfma_f32_16x16x32_bf16 v[120:123], v[248:251], a[188:191], v[120:123]
    ds_read_b64_tr_b16 v[220:221], v17 offset:0
    v_mfma_f32_16x16x32_bf16 v[76:79], v[236:239], a[160:163], v[76:79]
    ds_read_b64_tr_b16 v[222:223], v17 offset:2048
    v_mfma_f32_16x16x32_bf16 v[76:79], v[252:255], a[176:179], v[76:79]
    v_mfma_f32_16x16x32_bf16 v[92:95], v[236:239], a[164:167], v[92:95]
    buffer_load_dwordx4 v10, s[24:27], s100 offen offset:2048 lds
    v_mfma_f32_16x16x32_bf16 v[92:95], v[252:255], a[180:183], v[92:95]
    v_mfma_f32_16x16x32_bf16 v[108:111], v[236:239], a[168:171], v[108:111]
    v_mfma_f32_16x16x32_bf16 v[108:111], v[252:255], a[184:187], v[108:111]
    v_mfma_f32_16x16x32_bf16 v[124:127], v[236:239], a[172:175], v[124:127]
    buffer_load_dwordx4 v11, s[24:27], s100 offen offset:3072 lds
    v_mfma_f32_16x16x32_bf16 v[124:127], v[252:255], a[188:191], v[124:127]
    s_waitcnt vmcnt(8)
    v_cmp_ne_u32 vcc, s49, v7
    s_nop 0
    s_cbranch_vccnz L_poll_retry_22
L_poll_ok_23:
    s_waitcnt lgkmcnt(0)
    v_mfma_f32_16x16x32_bf16 v[64:67], v[192:195], a[192:195], v[64:67]
    v_mfma_f32_16x16x32_bf16 v[64:67], v[208:211], a[208:211], v[64:67]
    v_mfma_f32_16x16x32_bf16 v[80:83], v[192:195], a[196:199], v[80:83]
    ds_read_b64_tr_b16 v[224:225], v14 offset:16384
    s_lshl2_add_u32 s101, s44, s47
    s_lshl_b32 s101, s101, 12
    v_mfma_f32_16x16x32_bf16 v[80:83], v[208:211], a[212:215], v[80:83]
    ds_read_b64_tr_b16 v[226:227], v14 offset:18432
    v_add_u32 v50, 229376, v50
    v_mfma_f32_16x16x32_bf16 v[96:99], v[192:195], a[200:203], v[96:99]
    buffer_load_dwordx4 a[224:227], v50, s[32:35], s101 offen offset:0 sc1
    v_mfma_f32_16x16x32_bf16 v[96:99], v[208:211], a[216:219], v[96:99]
    ds_read_b64_tr_b16 v[240:241], v14 offset:32768
    v_mfma_f32_16x16x32_bf16 v[112:115], v[192:195], a[204:207], v[112:115]
    ds_read_b64_tr_b16 v[242:243], v14 offset:34816
    v_mfma_f32_16x16x32_bf16 v[112:115], v[208:211], a[220:223], v[112:115]
    ds_read_b64_tr_b16 v[228:229], v15 offset:16384
    v_mfma_f32_16x16x32_bf16 v[68:71], v[196:199], a[192:195], v[68:71]
    buffer_load_dwordx4 a[228:231], v50, s[32:35], s101 offen offset:1024 sc1
    v_mfma_f32_16x16x32_bf16 v[68:71], v[212:215], a[208:211], v[68:71]
    ds_read_b64_tr_b16 v[230:231], v15 offset:18432
    v_mfma_f32_16x16x32_bf16 v[84:87], v[196:199], a[196:199], v[84:87]
    ds_read_b64_tr_b16 v[244:245], v15 offset:32768
    v_mfma_f32_16x16x32_bf16 v[84:87], v[212:215], a[212:215], v[84:87]
    ds_read_b64_tr_b16 v[246:247], v15 offset:34816
    v_mfma_f32_16x16x32_bf16 v[100:103], v[196:199], a[200:203], v[100:103]
    buffer_load_dwordx4 a[232:235], v50, s[32:35], s101 offen offset:2048 sc1
    v_mfma_f32_16x16x32_bf16 v[100:103], v[212:215], a[216:219], v[100:103]
    v_mfma_f32_16x16x32_bf16 v[116:119], v[196:199], a[204:207], v[116:119]
    ds_read_b64_tr_b16 v[232:233], v16 offset:16384
    v_mfma_f32_16x16x32_bf16 v[116:119], v[212:215], a[220:223], v[116:119]
    buffer_load_dwordx4 a[236:239], v50, s[32:35], s101 offen offset:3072 sc1
    v_mfma_f32_16x16x32_bf16 v[72:75], v[200:203], a[192:195], v[72:75]
    ds_read_b64_tr_b16 v[234:235], v16 offset:18432
    v_mfma_f32_16x16x32_bf16 v[72:75], v[216:219], a[208:211], v[72:75]
    ds_read_b64_tr_b16 v[248:249], v16 offset:32768
    v_mfma_f32_16x16x32_bf16 v[88:91], v[200:203], a[196:199], v[88:91]
    ds_read_b64_tr_b16 v[250:251], v16 offset:34816
    s_xor_b32 s101, s101, 4096
    v_mfma_f32_16x16x32_bf16 v[88:91], v[216:219], a[212:215], v[88:91]
    buffer_load_dwordx4 a[240:243], v50, s[32:35], s101 offen offset:0 sc1
    v_mfma_f32_16x16x32_bf16 v[104:107], v[200:203], a[200:203], v[104:107]
    ds_read_b64_tr_b16 v[236:237], v17 offset:16384
    v_mfma_f32_16x16x32_bf16 v[104:107], v[216:219], a[216:219], v[104:107]
    ds_read_b64_tr_b16 v[238:239], v17 offset:18432
    v_mfma_f32_16x16x32_bf16 v[120:123], v[200:203], a[204:207], v[120:123]
    buffer_load_dwordx4 a[244:247], v50, s[32:35], s101 offen offset:1024 sc1
    v_mfma_f32_16x16x32_bf16 v[120:123], v[216:219], a[220:223], v[120:123]
    ds_read_b64_tr_b16 v[252:253], v17 offset:32768
    v_mfma_f32_16x16x32_bf16 v[76:79], v[204:207], a[192:195], v[76:79]
    ds_read_b64_tr_b16 v[254:255], v17 offset:34816
    v_mfma_f32_16x16x32_bf16 v[76:79], v[220:223], a[208:211], v[76:79]
    v_mfma_f32_16x16x32_bf16 v[92:95], v[204:207], a[196:199], v[92:95]
    buffer_load_dwordx4 a[248:251], v50, s[32:35], s101 offen offset:2048 sc1
    v_mfma_f32_16x16x32_bf16 v[92:95], v[220:223], a[212:215], v[92:95]
    v_mfma_f32_16x16x32_bf16 v[108:111], v[204:207], a[200:203], v[108:111]
    v_mfma_f32_16x16x32_bf16 v[108:111], v[220:223], a[216:219], v[108:111]
    v_mfma_f32_16x16x32_bf16 v[124:127], v[204:207], a[204:207], v[124:127]
    buffer_load_dwordx4 a[252:255], v50, s[32:35], s101 offen offset:3072 sc1
    v_mfma_f32_16x16x32_bf16 v[124:127], v[220:223], a[220:223], v[124:127]
    s_waitcnt vmcnt(7) lgkmcnt(2)
    v_mfma_f32_16x16x32_bf16 v[64:67], v[224:227], a[224:227], v[64:67]
    s_waitcnt vmcnt(6)
    v_mfma_f32_16x16x32_bf16 v[80:83], v[224:227], a[228:231], v[80:83]
    s_waitcnt lgkmcnt(0)
    s_waitcnt vmcnt(5)
    v_mfma_f32_16x16x32_bf16 v[96:99], v[224:227], a[232:235], v[96:99]
    ds_read_b64_tr_b16 v[192:193], v14 offset:49152
    ds_read_b64_tr_b16 v[194:195], v14 offset:51200
    s_xor_b32 s101, s101, 12288
    s_waitcnt vmcnt(4)
    v_mfma_f32_16x16x32_bf16 v[112:115], v[224:227], a[236:239], v[112:115]
    ds_read_b64_tr_b16 v[208:209], v42 offset:0
    buffer_load_dwordx4 a[0:3], v50, s[32:35], s101 offen offset:0 sc1
    v_mfma_f32_16x16x32_bf16 v[68:71], v[228:231], a[224:227], v[68:71]
    ds_read_b64_tr_b16 v[210:211], v42 offset:2048
    ds_read_b64_tr_b16 v[196:197], v15 offset:49152
    v_mfma_f32_16x16x32_bf16 v[84:87], v[228:231], a[228:231], v[84:87]
    ds_read_b64_tr_b16 v[198:199], v15 offset:51200
    buffer_load_dwordx4 a[4:7], v50, s[32:35], s101 offen offset:1024 sc1
    v_mfma_f32_16x16x32_bf16 v[100:103], v[228:231], a[232:235], v[100:103]
    ds_read_b64_tr_b16 v[212:213], v43 offset:0
    v_mfma_f32_16x16x32_bf16 v[116:119], v[228:231], a[236:239], v[116:119]
    ds_read_b64_tr_b16 v[214:215], v43 offset:2048
    buffer_load_dwordx4 a[8:11], v50, s[32:35], s101 offen offset:2048 sc1
    v_mfma_f32_16x16x32_bf16 v[72:75], v[232:235], a[224:227], v[72:75]
    ds_read_b64_tr_b16 v[200:201], v16 offset:49152
    buffer_load_dwordx4 a[12:15], v50, s[32:35], s101 offen offset:3072 sc1
    v_mfma_f32_16x16x32_bf16 v[88:91], v[232:235], a[228:231], v[88:91]
    ds_read_b64_tr_b16 v[202:203], v16 offset:51200
    s_xor_b32 s101, s101, 4096
    v_mfma_f32_16x16x32_bf16 v[104:107], v[232:235], a[232:235], v[104:107]
    ds_read_b64_tr_b16 v[216:217], v44 offset:0
    buffer_load_dwordx4 a[16:19], v50, s[32:35], s101 offen offset:0 sc1
    v_mfma_f32_16x16x32_bf16 v[120:123], v[232:235], a[236:239], v[120:123]
    ds_read_b64_tr_b16 v[218:219], v44 offset:2048
    buffer_load_dwordx4 a[20:23], v50, s[32:35], s101 offen offset:1024 sc1
    v_mfma_f32_16x16x32_bf16 v[76:79], v[236:239], a[224:227], v[76:79]
    ds_read_b64_tr_b16 v[204:205], v17 offset:49152
    v_mfma_f32_16x16x32_bf16 v[92:95], v[236:239], a[228:231], v[92:95]
    ds_read_b64_tr_b16 v[206:207], v17 offset:51200
    buffer_load_dwordx4 a[24:27], v50, s[32:35], s101 offen offset:2048 sc1
    v_mfma_f32_16x16x32_bf16 v[108:111], v[236:239], a[232:235], v[108:111]
    ds_read_b64_tr_b16 v[220:221], v45 offset:0
    v_mfma_f32_16x16x32_bf16 v[124:127], v[236:239], a[236:239], v[124:127]
    ds_read_b64_tr_b16 v[222:223], v45 offset:2048
    buffer_load_dwordx4 a[28:31], v50, s[32:35], s101 offen offset:3072 sc1
    v_xor_b32 v173, 32, v46
    v_xor_b32 v174, 64, v46
    v_xor_b32 v175, 96, v46
    v_xor_b32 v172, 128, v47
    s_waitcnt vmcnt(11)
    v_mfma_f32_16x16x32_bf16 v[64:67], v[240:243], a[240:243], v[64:67]
    s_waitcnt vmcnt(7) lgkmcnt(3)
    v_mfma_f32_16x16x32_bf16 v[64:67], v[192:195], a[0:3], v[64:67]
    s_waitcnt lgkmcnt(0)
    s_waitcnt vmcnt(3)
    v_mfma_f32_16x16x32_bf16 v[64:67], v[208:211], a[16:19], v[64:67]
    v_lshlrev_b32 v140, 16, v136
    v_and_b32 v141, 0xffff0000, v136
    v_mfma_f32_16x16x32_bf16 v[80:83], v[240:243], a[244:247], v[80:83]
    v_lshlrev_b32 v142, 16, v137
    v_and_b32 v143, 0xffff0000, v137
    v_mfma_f32_16x16x32_bf16 v[80:83], v[192:195], a[4:7], v[80:83]
    v_lshlrev_b32 v144, 16, v138
    v_and_b32 v145, 0xffff0000, v138
    s_waitcnt vmcnt(2)
    v_mfma_f32_16x16x32_bf16 v[80:83], v[208:211], a[20:23], v[80:83]
    v_lshlrev_b32 v146, 16, v139
    v_and_b32 v147, 0xffff0000, v139
    v_mfma_f32_16x16x32_bf16 v[96:99], v[240:243], a[248:251], v[96:99]
    v_lshlrev_b32 v148, 16, v128
    v_and_b32 v149, 0xffff0000, v128
    v_mfma_f32_16x16x32_bf16 v[96:99], v[192:195], a[8:11], v[96:99]
    v_lshlrev_b32 v150, 16, v129
    v_and_b32 v151, 0xffff0000, v129
    s_waitcnt vmcnt(1)
    v_mfma_f32_16x16x32_bf16 v[96:99], v[208:211], a[24:27], v[96:99]
    ds_write_b128 v46, v[64:67] offset:0
    v_mfma_f32_16x16x32_bf16 v[112:115], v[240:243], a[252:255], v[112:115]
    v_lshlrev_b32 v152, 16, v130
    v_and_b32 v153, 0xffff0000, v130
    v_mfma_f32_16x16x32_bf16 v[112:115], v[192:195], a[12:15], v[112:115]
    v_lshlrev_b32 v154, 16, v131
    v_and_b32 v155, 0xffff0000, v131
    s_waitcnt vmcnt(0)
    v_mfma_f32_16x16x32_bf16 v[112:115], v[208:211], a[28:31], v[112:115]
    ds_write_b128 v46, v[80:83] offset:16384
    v_mfma_f32_16x16x32_bf16 v[68:71], v[244:247], a[240:243], v[68:71]
    v_add_f32 v148, v148, v140
    v_add_f32 v149, v149, v141
    v_mfma_f32_16x16x32_bf16 v[68:71], v[196:199], a[0:3], v[68:71]
    v_add_f32 v150, v150, v142
    v_add_f32 v151, v151, v143
    v_mfma_f32_16x16x32_bf16 v[68:71], v[212:215], a[16:19], v[68:71]
    ds_write_b128 v46, v[96:99] offset:32768
    v_mfma_f32_16x16x32_bf16 v[84:87], v[244:247], a[244:247], v[84:87]
    v_add_f32 v152, v152, v144
    v_add_f32 v153, v153, v145
    v_mfma_f32_16x16x32_bf16 v[84:87], v[196:199], a[4:7], v[84:87]
    v_add_f32 v154, v154, v146
    v_add_f32 v155, v155, v147
    v_mfma_f32_16x16x32_bf16 v[84:87], v[212:215], a[20:23], v[84:87]
    ds_write_b128 v46, v[112:115] offset:49152
    v_mfma_f32_16x16x32_bf16 v[100:103], v[244:247], a[248:251], v[100:103]
    v_lshlrev_b32 v156, 16, v132
    v_and_b32 v157, 0xffff0000, v132
    v_mfma_f32_16x16x32_bf16 v[100:103], v[196:199], a[8:11], v[100:103]
    v_lshlrev_b32 v158, 16, v133
    v_and_b32 v159, 0xffff0000, v133
    v_mfma_f32_16x16x32_bf16 v[100:103], v[212:215], a[24:27], v[100:103]
    ds_write_b128 v173, v[68:71] offset:0
    v_mfma_f32_16x16x32_bf16 v[116:119], v[244:247], a[252:255], v[116:119]
    v_lshlrev_b32 v160, 16, v134
    v_and_b32 v161, 0xffff0000, v134
    v_mfma_f32_16x16x32_bf16 v[116:119], v[196:199], a[12:15], v[116:119]
    v_lshlrev_b32 v162, 16, v135
    v_and_b32 v163, 0xffff0000, v135
    v_mfma_f32_16x16x32_bf16 v[116:119], v[212:215], a[28:31], v[116:119]
    ds_write_b128 v173, v[84:87] offset:16384
    v_mfma_f32_16x16x32_bf16 v[72:75], v[248:251], a[240:243], v[72:75]
    v_add_f32 v156, v156, v140
    v_add_f32 v157, v157, v141
    v_mfma_f32_16x16x32_bf16 v[72:75], v[200:203], a[0:3], v[72:75]
    v_add_f32 v158, v158, v142
    v_add_f32 v159, v159, v143
    v_mfma_f32_16x16x32_bf16 v[72:75], v[216:219], a[16:19], v[72:75]
    ds_write_b128 v173, v[100:103] offset:32768
    v_mfma_f32_16x16x32_bf16 v[88:91], v[248:251], a[244:247], v[88:91]
    v_add_f32 v160, v160, v144
    v_add_f32 v161, v161, v145
    v_mfma_f32_16x16x32_bf16 v[88:91], v[200:203], a[4:7], v[88:91]
    v_add_f32 v162, v162, v146
    v_add_f32 v163, v163, v147
    v_mfma_f32_16x16x32_bf16 v[88:91], v[216:219], a[20:23], v[88:91]
    ds_write_b128 v173, v[116:119] offset:49152
    v_mfma_f32_16x16x32_bf16 v[104:107], v[248:251], a[248:251], v[104:107]
    v_mfma_f32_16x16x32_bf16 v[104:107], v[200:203], a[8:11], v[104:107]
    v_mfma_f32_16x16x32_bf16 v[104:107], v[216:219], a[24:27], v[104:107]
    ds_write_b128 v174, v[72:75] offset:0
    v_mfma_f32_16x16x32_bf16 v[120:123], v[248:251], a[252:255], v[120:123]
    v_mfma_f32_16x16x32_bf16 v[120:123], v[200:203], a[12:15], v[120:123]
    v_mfma_f32_16x16x32_bf16 v[120:123], v[216:219], a[28:31], v[120:123]
    ds_write_b128 v174, v[88:91] offset:16384
    v_mfma_f32_16x16x32_bf16 v[76:79], v[252:255], a[240:243], v[76:79]
    v_mfma_f32_16x16x32_bf16 v[76:79], v[204:207], a[0:3], v[76:79]
    v_mfma_f32_16x16x32_bf16 v[76:79], v[220:223], a[16:19], v[76:79]
    ds_write_b128 v174, v[104:107] offset:32768
    v_mfma_f32_16x16x32_bf16 v[92:95], v[252:255], a[244:247], v[92:95]
    v_mfma_f32_16x16x32_bf16 v[92:95], v[204:207], a[4:7], v[92:95]
    v_mfma_f32_16x16x32_bf16 v[92:95], v[220:223], a[20:23], v[92:95]
    ds_write_b128 v174, v[120:123] offset:49152
    v_mfma_f32_16x16x32_bf16 v[108:111], v[252:255], a[248:251], v[108:111]
    v_mfma_f32_16x16x32_bf16 v[108:111], v[204:207], a[8:11], v[108:111]
    v_mfma_f32_16x16x32_bf16 v[108:111], v[220:223], a[24:27], v[108:111]
    ds_write_b128 v175, v[76:79] offset:0
    v_mfma_f32_16x16x32_bf16 v[124:127], v[252:255], a[252:255], v[124:127]
    v_mfma_f32_16x16x32_bf16 v[124:127], v[204:207], a[12:15], v[124:127]
    v_mfma_f32_16x16x32_bf16 v[124:127], v[220:223], a[28:31], v[124:127]
    ds_write_b128 v175, v[92:95] offset:16384
    s_nop 2
    ds_write_b128 v175, v[108:111] offset:32768
    s_nop 2
    ds_write_b128 v175, v[124:127] offset:49152
    s_waitcnt lgkmcnt(0)
    s_barrier
    ds_read_b128 v[64:67], v47 offset:0
    ds_read_b128 v[68:71], v172 offset:0
    ds_read_b128 v[72:75], v47 offset:4096
    ds_read_b128 v[76:79], v172 offset:4096
    ds_read_b128 v[80:83], v47 offset:8192
    ds_read_b128 v[84:87], v172 offset:8192
    ds_read_b128 v[88:91], v47 offset:12288
    ds_read_b128 v[92:95], v172 offset:12288
    ds_read_b128 v[96:99], v47 offset:2048
    ds_read_b128 v[100:103], v172 offset:2048
    ds_read_b128 v[104:107], v47 offset:6144
    ds_read_b128 v[108:111], v172 offset:6144
    ds_read_b128 v[112:115], v47 offset:10240
    ds_read_b128 v[116:119], v172 offset:10240
    ds_read_b128 v[120:123], v47 offset:14336
    ds_read_b128 v[124:127], v172 offset:14336
    s_waitcnt lgkmcnt(13)
    v_pk_add_f32 v[148:149], v[148:149], v[64:65]
    v_pk_add_f32 v[150:151], v[150:151], v[66:67]
    v_pk_add_f32 v[152:153], v[152:153], v[68:69]
    v_pk_add_f32 v[154:155], v[154:155], v[70:71]
    v_pk_add_f32 v[148:149], v[148:149], v[72:73]
    v_pk_add_f32 v[150:151], v[150:151], v[74:75]
    s_waitcnt lgkmcnt(6)
    v_pk_add_f32 v[152:153], v[152:153], v[76:77]
    v_pk_add_f32 v[154:155], v[154:155], v[78:79]
    v_pk_add_f32 v[148:149], v[148:149], v[80:81]
    v_pk_add_f32 v[150:151], v[150:151], v[82:83]
    v_pk_add_f32 v[152:153], v[152:153], v[84:85]
    v_pk_add_f32 v[154:155], v[154:155], v[86:87]
    v_pk_add_f32 v[148:149], v[148:149], v[88:89]
    v_pk_add_f32 v[150:151], v[150:151], v[90:91]
    v_pk_add_f32 v[152:153], v[152:153], v[92:93]
    v_pk_add_f32 v[154:155], v[154:155], v[94:95]
    v_cvt_pk_bf16_f32 v164, v148, v149
    v_cvt_pk_bf16_f32 v165, v150, v151
    v_cvt_pk_bf16_f32 v166, v152, v153
    v_cvt_pk_bf16_f32 v167, v154, v155
    buffer_store_dwordx4 v[164:167], v40, s[28:31], s3 offen sc1
    v_pk_add_f32 v[156:157], v[156:157], v[96:97]
    v_pk_add_f32 v[158:159], v[158:159], v[98:99]
    v_pk_add_f32 v[160:161], v[160:161], v[100:101]
    v_pk_add_f32 v[162:163], v[162:163], v[102:103]
    s_waitcnt lgkmcnt(0)
    v_pk_add_f32 v[156:157], v[156:157], v[104:105]
    v_pk_add_f32 v[158:159], v[158:159], v[106:107]
    v_pk_add_f32 v[160:161], v[160:161], v[108:109]
    v_pk_add_f32 v[162:163], v[162:163], v[110:111]
    v_pk_add_f32 v[156:157], v[156:157], v[112:113]
    v_pk_add_f32 v[158:159], v[158:159], v[114:115]
    v_pk_add_f32 v[160:161], v[160:161], v[116:117]
    v_pk_add_f32 v[162:163], v[162:163], v[118:119]
    v_pk_add_f32 v[156:157], v[156:157], v[120:121]
    v_pk_add_f32 v[158:159], v[158:159], v[122:123]
    v_pk_add_f32 v[160:161], v[160:161], v[124:125]
    v_pk_add_f32 v[162:163], v[162:163], v[126:127]
    v_cvt_pk_bf16_f32 v168, v156, v157
    v_cvt_pk_bf16_f32 v169, v158, v159
    v_cvt_pk_bf16_f32 v170, v160, v161
    v_cvt_pk_bf16_f32 v171, v162, v163
    s_add_u32 s3, s3, 8192
    buffer_store_dwordx4 v[168:171], v40, s[28:31], s3 offen sc1
    s_endpgm
L_st_retry_1:
    s_sub_u32 s57, s57, 1
    s_cbranch_scc1 L_end
    buffer_load_dwordx2 v[72:73], v33, s[32:35], s36 offen offset:0 sc1
    buffer_load_dwordx2 v[74:75], v33, s[32:35], s36 offen offset:128 sc1
    buffer_load_dwordx2 v[76:77], v33, s[32:35], s36 offen offset:256 sc1
    buffer_load_dwordx2 v[78:79], v33, s[32:35], s36 offen offset:384 sc1
    s_waitcnt vmcnt(0)
    v_xor_b32 v34, s49, v73
    v_bitop3_b32 v34, v34, s49, v75 bitop3:0xf6
    v_bitop3_b32 v34, v34, s49, v77 bitop3:0xf6
    v_bitop3_b32 v34, v34, s49, v79 bitop3:0xf6
    v_cmp_ne_u32 vcc, 0, v34
    s_nop 0
    s_cbranch_vccnz L_st_retry_1
    s_branch L_st_ok_2
L_poll_retry_5:
    s_sub_u32 s57, s57, 1
    s_cbranch_scc1 L_end
    buffer_load_dword v7, v5, s[32:35], 0 offen sc1
    s_waitcnt vmcnt(0)
    v_cmp_ne_u32 vcc, s49, v7
    s_nop 0
    s_cbranch_vccnz L_poll_retry_5
    s_branch L_poll_ok_6
L_light_3:
    v_pk_fma_f32 v[244:245], v[88:89], v[72:73], v[56:57] op_sel:[0,1,0] op_sel_hi:[1,1,1]
    v_pk_fma_f32 v[246:247], v[90:91], v[72:73], v[58:59] op_sel:[0,1,0] op_sel_hi:[1,1,1]
    v_pk_fma_f32 v[204:205], v[204:205], v[72:73], v[244:245] op_sel_hi:[1,0,1]
    v_pk_fma_f32 v[206:207], v[206:207], v[72:73], v[246:247] op_sel_hi:[1,0,1]
    v_max_f32 v204, 0, v204
    v_max_f32 v205, 0, v205
    v_max_f32 v206, 0, v206
    v_max_f32 v207, 0, v207
    v_pk_mul_f32 v[204:205], v[204:205], v[204:205]
    v_pk_mul_f32 v[206:207], v[206:207], v[206:207]
    v_cvt_pk_bf16_f32 v236, v204, v205
    v_cvt_pk_bf16_f32 v237, v206, v207
    v_pk_fma_f32 v[244:245], v[92:93], v[72:73], v[60:61] op_sel:[0,1,0] op_sel_hi:[1,1,1]
    v_pk_fma_f32 v[246:247], v[94:95], v[72:73], v[62:63] op_sel:[0,1,0] op_sel_hi:[1,1,1]
    v_pk_fma_f32 v[220:221], v[220:221], v[72:73], v[244:245] op_sel_hi:[1,0,1]
    v_pk_fma_f32 v[222:223], v[222:223], v[72:73], v[246:247] op_sel_hi:[1,0,1]
    v_max_f32 v220, 0, v220
    v_max_f32 v221, 0, v221
    v_max_f32 v222, 0, v222
    v_max_f32 v223, 0, v223
    v_pk_mul_f32 v[220:221], v[220:221], v[220:221]
    v_pk_mul_f32 v[222:223], v[222:223], v[222:223]
    v_cvt_pk_bf16_f32 v238, v220, v221
    v_cvt_pk_bf16_f32 v239, v222, v223
    buffer_store_dwordx4 v[236:239], v1, s[32:35], s61 offen offset:0 sc1
    v_pk_fma_f32 v[244:245], v[88:89], v[74:75], v[56:57] op_sel:[0,1,0] op_sel_hi:[1,1,1]
    v_pk_fma_f32 v[246:247], v[90:91], v[74:75], v[58:59] op_sel:[0,1,0] op_sel_hi:[1,1,1]
    v_pk_fma_f32 v[208:209], v[208:209], v[74:75], v[244:245] op_sel_hi:[1,0,1]
    v_pk_fma_f32 v[210:211], v[210:211], v[74:75], v[246:247] op_sel_hi:[1,0,1]
    v_max_f32 v208, 0, v208
    v_max_f32 v209, 0, v209
    v_max_f32 v210, 0, v210
    v_max_f32 v211, 0, v211
    v_pk_mul_f32 v[208:209], v[208:209], v[208:209]
    v_pk_mul_f32 v[210:211], v[210:211], v[210:211]
    v_cvt_pk_bf16_f32 v240, v208, v209
    v_cvt_pk_bf16_f32 v241, v210, v211
    v_pk_fma_f32 v[244:245], v[92:93], v[74:75], v[60:61] op_sel:[0,1,0] op_sel_hi:[1,1,1]
    v_pk_fma_f32 v[246:247], v[94:95], v[74:75], v[62:63] op_sel:[0,1,0] op_sel_hi:[1,1,1]
    v_pk_fma_f32 v[224:225], v[224:225], v[74:75], v[244:245] op_sel_hi:[1,0,1]
    v_pk_fma_f32 v[226:227], v[226:227], v[74:75], v[246:247] op_sel_hi:[1,0,1]
    v_max_f32 v224, 0, v224
    v_max_f32 v225, 0, v225
    v_max_f32 v226, 0, v226
    v_max_f32 v227, 0, v227
    v_pk_mul_f32 v[224:225], v[224:225], v[224:225]
    v_pk_mul_f32 v[226:227], v[226:227], v[226:227]
    v_cvt_pk_bf16_f32 v242, v224, v225
    v_cvt_pk_bf16_f32 v243, v226, v227
    buffer_store_dwordx4 v[240:243], v1, s[32:35], s61 offen offset:1024 sc1
    v_pk_fma_f32 v[244:245], v[88:89], v[76:77], v[56:57] op_sel:[0,1,0] op_sel_hi:[1,1,1]
    v_pk_fma_f32 v[246:247], v[90:91], v[76:77], v[58:59] op_sel:[0,1,0] op_sel_hi:[1,1,1]
    v_pk_fma_f32 v[212:213], v[212:213], v[76:77], v[244:245] op_sel_hi:[1,0,1]
    v_pk_fma_f32 v[214:215], v[214:215], v[76:77], v[246:247] op_sel_hi:[1,0,1]
    v_max_f32 v212, 0, v212
    v_max_f32 v213, 0, v213
    v_max_f32 v214, 0, v214
    v_max_f32 v215, 0, v215
    v_pk_mul_f32 v[212:213], v[212:213], v[212:213]
    v_pk_mul_f32 v[214:215], v[214:215], v[214:215]
    v_cvt_pk_bf16_f32 v236, v212, v213
    v_cvt_pk_bf16_f32 v237, v214, v215
    v_pk_fma_f32 v[244:245], v[92:93], v[76:77], v[60:61] op_sel:[0,1,0] op_sel_hi:[1,1,1]
    v_pk_fma_f32 v[246:247], v[94:95], v[76:77], v[62:63] op_sel:[0,1,0] op_sel_hi:[1,1,1]
    v_pk_fma_f32 v[228:229], v[228:229], v[76:77], v[244:245] op_sel_hi:[1,0,1]
    v_pk_fma_f32 v[230:231], v[230:231], v[76:77], v[246:247] op_sel_hi:[1,0,1]
    v_max_f32 v228, 0, v228
    v_max_f32 v229, 0, v229
    v_max_f32 v230, 0, v230
    v_max_f32 v231, 0, v231
    v_pk_mul_f32 v[228:229], v[228:229], v[228:229]
    v_pk_mul_f32 v[230:231], v[230:231], v[230:231]
    v_cvt_pk_bf16_f32 v238, v228, v229
    v_cvt_pk_bf16_f32 v239, v230, v231
    buffer_store_dwordx4 v[236:239], v1, s[32:35], s61 offen offset:2048 sc1
    v_pk_fma_f32 v[244:245], v[88:89], v[78:79], v[56:57] op_sel:[0,1,0] op_sel_hi:[1,1,1]
    v_pk_fma_f32 v[246:247], v[90:91], v[78:79], v[58:59] op_sel:[0,1,0] op_sel_hi:[1,1,1]
    v_pk_fma_f32 v[216:217], v[216:217], v[78:79], v[244:245] op_sel_hi:[1,0,1]
    v_pk_fma_f32 v[218:219], v[218:219], v[78:79], v[246:247] op_sel_hi:[1,0,1]
    v_max_f32 v216, 0, v216
    v_max_f32 v217, 0, v217
    v_max_f32 v218, 0, v218
    v_max_f32 v219, 0, v219
    v_pk_mul_f32 v[216:217], v[216:217], v[216:217]
    v_pk_mul_f32 v[218:219], v[218:219], v[218:219]
    v_cvt_pk_bf16_f32 v240, v216, v217
    v_cvt_pk_bf16_f32 v241, v218, v219
    v_pk_fma_f32 v[244:245], v[92:93], v[78:79], v[60:61] op_sel:[0,1,0] op_sel_hi:[1,1,1]
    v_pk_fma_f32 v[246:247], v[94:95], v[78:79], v[62:63] op_sel:[0,1,0] op_sel_hi:[1,1,1]
    v_pk_fma_f32 v[232:233], v[232:233], v[78:79], v[244:245] op_sel_hi:[1,0,1]
    v_pk_fma_f32 v[234:235], v[234:235], v[78:79], v[246:247] op_sel_hi:[1,0,1]
    v_max_f32 v232, 0, v232
    v_max_f32 v233, 0, v233
    v_max_f32 v234, 0, v234
    v_max_f32 v235, 0, v235
    v_pk_mul_f32 v[232:233], v[232:233], v[232:233]
    v_pk_mul_f32 v[234:235], v[234:235], v[234:235]
    v_cvt_pk_bf16_f32 v242, v232, v233
    v_cvt_pk_bf16_f32 v243, v234, v235
    buffer_store_dwordx4 v[240:243], v1, s[32:35], s61 offen offset:3072 sc1
    v_mfma_f32_16x16x32_bf16 v[132:135], v[124:127], a[0:3], 0
    v_mfma_f32_16x16x32_bf16 v[132:135], v[128:131], a[16:19], v[132:135]
    s_barrier
    v_mfma_f32_16x16x32_bf16 v[136:139], v[124:127], a[4:7], 0
    ds_read_b64_tr_b16 v[156:157], v27 offset:16384
    s_add_u32 m0, s52, 65536
    s_add_u32 s51, s51, 1
    s_and_b32 s51, s51, 7
    s_mul_i32 s54, s51, 196608
    buffer_load_dwordx4 v22, s[12:15], s54 offen lds
    v_mfma_f32_16x16x32_bf16 v[136:139], v[128:131], a[20:23], v[136:139]
    ds_read_b64_tr_b16 v[158:159], v27 offset:16640
    s_mul_i32 s54, s51, 229376
    buffer_load_dwordx4 v20, s[16:19], s54 offen offset:2048 lds
    v_mfma_f32_16x16x32_bf16 v[164:167], v[124:127], a[8:11], 0
    buffer_load_dwordx4 v21, s[16:19], s54 offen offset:3072 lds
    v_mfma_f32_16x16x32_bf16 v[164:167], v[128:131], a[24:27], v[164:167]
    ds_read_b64_tr_b16 v[160:161], v27 offset:24576
    s_add_u32 m0, s52, 49152
    s_xor_b32 s100, s100, 98304
    buffer_load_dwordx4 v8, s[20:23], s100 offen offset:0 lds
    v_mfma_f32_16x16x32_bf16 v[168:171], v[124:127], a[12:15], 0
    buffer_load_dwordx4 v9, s[20:23], s100 offen offset:1024 lds
    v_mfma_f32_16x16x32_bf16 v[168:171], v[128:131], a[28:31], v[168:171]
    ds_read_b64_tr_b16 v[162:163], v27 offset:24832
    buffer_load_dwordx4 v10, s[20:23], s100 offen offset:2048 lds
    v_smfmac_f32_16x16x64_bf16 v[104:107], v[52:55], v[124:131], v28
    buffer_load_dwordx4 v11, s[20:23], s100 offen offset:3072 lds
    v_lshlrev_b32 v34, 3, v0
    v_add_u32 v34, 115840, v34
    ds_write_b64 v34, v[52:53]
    s_waitcnt vmcnt(7)
    s_mov_b32 s56, 0
    s_mov_b64 exec, 1
    buffer_store_dword v2, v3, s[32:35], s56 offen sc1
    s_mov_b64 exec, -1
    s_waitcnt lgkmcnt(2)
    v_mfma_f32_16x16x32_bf16 v[132:135], v[156:159], a[32:35], v[132:135]
    s_waitcnt lgkmcnt(1)
    v_mfma_f32_16x16x32_bf16 v[132:135], v[160:163], a[48:51], v[132:135]
    s_waitcnt lgkmcnt(0)
    s_barrier
    v_mfma_f32_16x16x32_bf16 v[136:139], v[156:159], a[36:39], v[136:139]
    ds_read_b64_tr_b16 v[124:125], v27 offset:32768
    s_add_u32 m0, s52, 81920
    s_add_u32 s51, s51, 1
    s_and_b32 s51, s51, 7
    v_mfma_f32_16x16x32_bf16 v[136:139], v[160:163], a[52:55], v[136:139]
    ds_read_b64_tr_b16 v[126:127], v27 offset:33024
    s_mul_i32 s54, s51, 196608
    v_mfma_f32_16x16x32_bf16 v[164:167], v[156:159], a[40:43], v[164:167]
    buffer_load_dwordx4 v22, s[12:15], s54 offen lds
    v_mfma_f32_16x16x32_bf16 v[164:167], v[160:163], a[56:59], v[164:167]
    ds_read_b64_tr_b16 v[128:129], v27 offset:40960
    s_mul_i32 s54, s51, 229376
    v_mfma_f32_16x16x32_bf16 v[168:171], v[156:159], a[44:47], v[168:171]
    buffer_load_dwordx4 v20, s[16:19], s54 offen offset:2048 lds
    v_mfma_f32_16x16x32_bf16 v[168:171], v[160:163], a[60:63], v[168:171]
    ds_read_b64_tr_b16 v[130:131], v27 offset:41216
    v_smfmac_f32_16x16x64_bf16 v[104:107], v[52:55], v[156:163], v28
    buffer_load_dwordx4 v21, s[16:19], s54 offen offset:3072 lds
    s_waitcnt lgkmcnt(2)
    v_mfma_f32_16x16x32_bf16 v[132:135], v[124:127], a[64:67], v[132:135]
    s_waitcnt lgkmcnt(0)
    v_mfma_f32_16x16x32_bf16 v[132:135], v[128:131], a[80:83], v[132:135]
    s_barrier
    v_mfma_f32_16x16x32_bf16 v[136:139], v[124:127], a[68:71], v[136:139]
    ds_read_b64_tr_b16 v[156:157], v27 offset:49152
    s_add_u32 m0, s52, 98304
    s_add_u32 s51, s51, 1
    s_and_b32 s51, s51, 7
    v_mfma_f32_16x16x32_bf16 v[136:139], v[128:131], a[84:87], v[136:139]
    ds_read_b64_tr_b16 v[158:159], v27 offset:49408
    s_mul_i32 s54, s51, 196608
    v_mfma_f32_16x16x32_bf16 v[164:167], v[124:127], a[72:75], v[164:167]
    buffer_load_dwordx4 v22, s[12:15], s54 offen lds
    v_mfma_f32_16x16x32_bf16 v[164:167], v[128:131], a[88:91], v[164:167]
    ds_read_b64_tr_b16 v[160:161], v27 offset:57344
    s_mul_i32 s54, s51, 229376
    v_mfma_f32_16x16x32_bf16 v[168:171], v[124:127], a[76:79], v[168:171]
    buffer_load_dwordx4 v20, s[16:19], s54 offen offset:2048 lds
    v_mfma_f32_16x16x32_bf16 v[168:171], v[128:131], a[92:95], v[168:171]
    ds_read_b64_tr_b16 v[162:163], v27 offset:57600
    v_smfmac_f32_16x16x64_bf16 v[104:107], v[52:55], v[124:131], v28
    buffer_load_dwordx4 v21, s[16:19], s54 offen offset:3072 lds
    s_waitcnt lgkmcnt(2)
    v_mfma_f32_16x16x32_bf16 v[132:135], v[156:159], a[96:99], v[132:135]
    s_waitcnt lgkmcnt(0)
    v_mfma_f32_16x16x32_bf16 v[132:135], v[160:163], a[112:115], v[132:135]
    s_waitcnt vmcnt(11)
    s_barrier
    v_mfma_f32_16x16x32_bf16 v[136:139], v[156:159], a[100:103], v[136:139]
    ds_read_b64_tr_b16 v[124:125], v27 offset:0
    s_add_u32 m0, s52, 114688
    s_add_u32 s51, s51, 1
    s_and_b32 s51, s51, 7
    v_mfma_f32_16x16x32_bf16 v[136:139], v[160:163], a[116:119], v[136:139]
    ds_read_b64_tr_b16 v[126:127], v27 offset:256
    s_mul_i32 s54, s51, 196608
    v_mfma_f32_16x16x32_bf16 v[164:167], v[156:159], a[104:107], v[164:167]
    buffer_load_dwordx4 v22, s[12:15], s54 offen lds
    v_mfma_f32_16x16x32_bf16 v[164:167], v[160:163], a[120:123], v[164:167]
    ds_read_b64_tr_b16 v[128:129], v27 offset:8192
    s_mul_i32 s54, s51, 229376
    v_mfma_f32_16x16x32_bf16 v[168:171], v[156:159], a[108:111], v[168:171]
    buffer_load_dwordx4 v20, s[16:19], s54 offen offset:2048 lds
    v_mfma_f32_16x16x32_bf16 v[168:171], v[160:163], a[124:127], v[168:171]
    ds_read_b64_tr_b16 v[130:131], v27 offset:8448
    v_smfmac_f32_16x16x64_bf16 v[104:107], v[52:55], v[156:163], v28
    buffer_load_dwordx4 v21, s[16:19], s54 offen offset:3072 lds
    buffer_load_dword v7, v5, s[32:35], 0 offen sc1
    s_waitcnt lgkmcnt(2)
    v_mfma_f32_16x16x32_bf16 v[132:135], v[124:127], a[128:131], v[132:135]
    s_waitcnt lgkmcnt(0)
    v_mfma_f32_16x16x32_bf16 v[132:135], v[128:131], a[144:147], v[132:135]
    s_waitcnt vmcnt(7)
    s_barrier
    v_mfma_f32_16x16x32_bf16 v[136:139], v[124:127], a[132:135], v[136:139]
    ds_read_b64_tr_b16 v[156:157], v27 offset:16384
    s_add_u32 m0, s52, 65536
    s_xor_b32 s100, s100, 32768
    v_mfma_f32_16x16x32_bf16 v[136:139], v[128:131], a[148:151], v[136:139]
    ds_read_b64_tr_b16 v[158:159], v27 offset:16640
    buffer_load_dwordx4 v8, s[20:23], s100 offen offset:0 lds
    v_mfma_f32_16x16x32_bf16 v[164:167], v[124:127], a[136:139], v[164:167]
    ds_read_b64_tr_b16 v[160:161], v27 offset:24576
    v_mfma_f32_16x16x32_bf16 v[164:167], v[128:131], a[152:155], v[164:167]
    buffer_load_dwordx4 v9, s[20:23], s100 offen offset:1024 lds
    v_mfma_f32_16x16x32_bf16 v[168:171], v[124:127], a[140:143], v[168:171]
    buffer_load_dwordx4 v10, s[20:23], s100 offen offset:2048 lds
    v_mfma_f32_16x16x32_bf16 v[168:171], v[128:131], a[156:159], v[168:171]
    ds_read_b64_tr_b16 v[162:163], v27 offset:24832
    v_smfmac_f32_16x16x64_bf16 v[104:107], v[52:55], v[124:131], v28
    buffer_load_dwordx4 v11, s[20:23], s100 offen offset:3072 lds
    s_waitcnt lgkmcnt(2)
    v_mfma_f32_16x16x32_bf16 v[132:135], v[156:159], a[160:163], v[132:135]
    s_waitcnt lgkmcnt(0)
    v_mfma_f32_16x16x32_bf16 v[132:135], v[160:163], a[176:179], v[132:135]
    s_waitcnt vmcnt(8)
    s_barrier
    v_mfma_f32_16x16x32_bf16 v[136:139], v[156:159], a[164:167], v[136:139]
    ds_read_b64_tr_b16 v[124:125], v27 offset:32768
    s_add_u32 m0, s52, 81920
    s_xor_b32 s100, s100, 229376
    v_mfma_f32_16x16x32_bf16 v[136:139], v[160:163], a[180:183], v[136:139]
    ds_read_b64_tr_b16 v[126:127], v27 offset:33024
    buffer_load_dwordx4 v8, s[20:23], s100 offen offset:0 lds
    v_mfma_f32_16x16x32_bf16 v[164:167], v[156:159], a[168:171], v[164:167]
    ds_read_b64_tr_b16 v[128:129], v27 offset:40960
    v_mfma_f32_16x16x32_bf16 v[164:167], v[160:163], a[184:187], v[164:167]
    buffer_load_dwordx4 v9, s[20:23], s100 offen offset:1024 lds
    v_mfma_f32_16x16x32_bf16 v[168:171], v[156:159], a[172:175], v[168:171]
    buffer_load_dwordx4 v10, s[20:23], s100 offen offset:2048 lds
    v_mfma_f32_16x16x32_bf16 v[168:171], v[160:163], a[188:191], v[168:171]
    ds_read_b64_tr_b16 v[130:131], v27 offset:41216
    v_smfmac_f32_16x16x64_bf16 v[104:107], v[52:55], v[156:163], v28
    buffer_load_dwordx4 v11, s[20:23], s100 offen offset:3072 lds
    s_waitcnt vmcnt(8)
    v_cmp_ne_u32 vcc, s49, v7
    s_nop 0
    s_cbranch_vccnz L_poll_retry_5
L_poll_ok_6:
    s_waitcnt lgkmcnt(0)
    v_mfma_f32_16x16x32_bf16 v[132:135], v[124:127], a[192:195], v[132:135]
    v_mfma_f32_16x16x32_bf16 v[132:135], v[128:131], a[208:211], v[132:135]
    s_barrier
    v_mfma_f32_16x16x32_bf16 v[136:139], v[124:127], a[196:199], v[136:139]
    ds_read_b64_tr_b16 v[156:157], v27 offset:49152
    s_add_u32 m0, s99, 0
    s_nop 0
    buffer_load_dwordx4 v1, s[32:35], s96 offen offset:0 sc1 lds
    v_mfma_f32_16x16x32_bf16 v[136:139], v[128:131], a[212:215], v[136:139]
    ds_read_b64_tr_b16 v[158:159], v27 offset:49408
    s_add_u32 s96, s96, 64512
    buffer_load_dwordx4 v1, s[32:35], s96 offen offset:1024 sc1 lds
    v_mfma_f32_16x16x32_bf16 v[164:167], v[124:127], a[200:203], v[164:167]
    s_add_u32 s96, s96, 2030592
    buffer_load_dwordx4 v1, s[32:35], s96 offen offset:2048 sc1 lds
    v_mfma_f32_16x16x32_bf16 v[164:167], v[128:131], a[216:219], v[164:167]
    ds_read_b64_tr_b16 v[160:161], v27 offset:57344
    s_add_u32 s96, s96, 64512
    buffer_load_dwordx4 v1, s[32:35], s96 offen offset:3072 sc1 lds
    v_mfma_f32_16x16x32_bf16 v[168:171], v[124:127], a[204:207], v[168:171]
    s_add_u32 m0, s99, 4096
    s_nop 0
    buffer_load_dwordx4 v1, s[32:35], s97 offen offset:0 sc1 lds
    v_mfma_f32_16x16x32_bf16 v[168:171], v[128:131], a[220:223], v[168:171]
    ds_read_b64_tr_b16 v[162:163], v27 offset:57600
    s_add_u32 s97, s97, 64512
    buffer_load_dwordx4 v1, s[32:35], s97 offen offset:1024 sc1 lds
    v_smfmac_f32_16x16x64_bf16 v[104:107], v[52:55], v[124:131], v28
    s_add_u32 s97, s97, 2030592
    buffer_load_dwordx4 v1, s[32:35], s97 offen offset:2048 sc1 lds
    s_add_u32 s97, s97, 64512
    buffer_load_dwordx4 v1, s[32:35], s97 offen offset:3072 sc1 lds
    s_add_u32 m0, s52, 98304
    s_xor_b32 s100, s100, 32768
    buffer_load_dwordx4 v8, s[20:23], s100 offen offset:0 lds
    buffer_load_dwordx4 v9, s[20:23], s100 offen offset:1024 lds
    buffer_load_dwordx4 v10, s[20:23], s100 offen offset:2048 lds
    buffer_load_dwordx4 v11, s[20:23], s100 offen offset:3072 lds
    s_waitcnt lgkmcnt(0)
    v_smfmac_f32_16x16x64_bf16 v[104:107], v[52:55], v[156:163], v28
    v_mfma_f32_16x16x32_bf16 v[132:135], v[156:159], a[224:227], v[132:135]
    v_mfma_f32_16x16x32_bf16 v[132:135], v[160:163], a[240:243], v[132:135]
    v_mfma_f32_16x16x32_bf16 v[136:139], v[156:159], a[228:231], v[136:139]
    s_nop 8
    v_add_f32 v104, v104, v105
    ds_write_b32 v31, v104 offset:51072
    v_mfma_f32_16x16x32_bf16 v[136:139], v[160:163], a[244:247], v[136:139]
    v_mfma_f32_16x16x32_bf16 v[164:167], v[156:159], a[232:235], v[164:167]
    v_mfma_f32_16x16x32_bf16 v[164:167], v[160:163], a[248:251], v[164:167]
    v_mfma_f32_16x16x32_bf16 v[168:171], v[156:159], a[236:239], v[168:171]
    s_waitcnt lgkmcnt(0)
    s_barrier
    v_mfma_f32_16x16x32_bf16 v[168:171], v[160:163], a[252:255], v[168:171]
    ds_read_b128 v[104:107], v32 offset:51072
    s_add_u32 m0, s99, 8192
    s_nop 0
    buffer_load_dwordx4 v1, s[32:35], s98 offen offset:0 sc1 lds
    s_add_u32 s98, s98, 64512
    buffer_load_dwordx4 v1, s[32:35], s98 offen offset:1024 sc1 lds
    s_add_u32 s98, s98, 2030592
    buffer_load_dwordx4 v1, s[32:35], s98 offen offset:2048 sc1 lds
    s_add_u32 s98, s98, 64512
    buffer_load_dwordx4 v1, s[32:35], s98 offen offset:3072 sc1 lds
    s_mov_b32 s62, 0x40000000
    buffer_store_dwordx4 v[236:239], v1, s[32:35], s62 offen sc1
    buffer_store_dwordx4 v[236:239], v1, s[32:35], s62 offen sc1
    buffer_store_dwordx4 v[236:239], v1, s[32:35], s62 offen sc1
    buffer_store_dwordx4 v[236:239], v1, s[32:35], s62 offen sc1
    s_mov_b32 s53, 0x3eb8aa3b
    s_mov_b32 s54, 0x3eb8aa3b
    v_mul_f32 v72, s53, v72
    v_mul_f32 v73, s53, v73
    v_mul_f32 v74, s53, v74
    v_mul_f32 v75, s53, v75
    v_mul_f32 v76, s53, v76
    v_mul_f32 v77, s53, v77
    v_mul_f32 v78, s53, v78
    v_mul_f32 v79, s53, v79
    s_waitcnt lgkmcnt(0)
    v_pk_mul_f32 v[80:81], v[104:105], v[72:73] op_sel:[0,1] op_sel_hi:[1,1]
    v_pk_mul_f32 v[82:83], v[106:107], v[72:73] op_sel:[0,1] op_sel_hi:[1,1]
    v_pk_fma_f32 v[132:133], v[132:133], v[72:73], v[80:81] op_sel_hi:[1,0,1]
    v_pk_fma_f32 v[134:135], v[134:135], v[72:73], v[82:83] op_sel_hi:[1,0,1]
    v_pk_mul_f32 v[84:85], v[104:105], v[74:75] op_sel:[0,1] op_sel_hi:[1,1]
    v_pk_mul_f32 v[86:87], v[106:107], v[74:75] op_sel:[0,1] op_sel_hi:[1,1]
    v_pk_fma_f32 v[136:137], v[136:137], v[74:75], v[84:85] op_sel_hi:[1,0,1]
    v_pk_fma_f32 v[138:139], v[138:139], v[74:75], v[86:87] op_sel_hi:[1,0,1]
    v_cvt_pk_bf16_f32 v56, v132, v133
    v_cvt_pk_bf16_f32 v57, v134, v135
    v_cvt_pk_bf16_f32 v58, v136, v137
    v_cvt_pk_bf16_f32 v59, v138, v139
    s_nop 0
    v_permlane16_swap_b32 v56, v58
    v_permlane16_swap_b32 v57, v59
    v_pk_mul_f32 v[80:81], v[104:105], v[76:77] op_sel:[0,1] op_sel_hi:[1,1]
    v_pk_mul_f32 v[82:83], v[106:107], v[76:77] op_sel:[0,1] op_sel_hi:[1,1]
    v_pk_fma_f32 v[164:165], v[164:165], v[76:77], v[80:81] op_sel_hi:[1,0,1]
    v_pk_fma_f32 v[166:167], v[166:167], v[76:77], v[82:83] op_sel_hi:[1,0,1]
    v_pk_mul_f32 v[84:85], v[104:105], v[78:79] op_sel:[0,1] op_sel_hi:[1,1]
    v_pk_mul_f32 v[86:87], v[106:107], v[78:79] op_sel:[0,1] op_sel_hi:[1,1]
    v_pk_fma_f32 v[168:169], v[168:169], v[78:79], v[84:85] op_sel_hi:[1,0,1]
    v_pk_fma_f32 v[170:171], v[170:171], v[78:79], v[86:87] op_sel_hi:[1,0,1]
    v_cvt_pk_bf16_f32 v60, v164, v165
    v_cvt_pk_bf16_f32 v61, v166, v167
    v_cvt_pk_bf16_f32 v62, v168, v169
    v_cvt_pk_bf16_f32 v63, v170, v171
    s_nop 0
    v_permlane16_swap_b32 v60, v62
    v_permlane16_swap_b32 v61, v63
    s_waitcnt lgkmcnt(0)
    s_nop 0
    s_branch L_join_4
L_poll_retry_7:
    s_sub_u32 s57, s57, 1
    s_cbranch_scc1 L_end
    buffer_load_dword v7, v5, s[32:35], 0 offen sc1
    s_waitcnt vmcnt(0)
    v_cmp_ne_u32 vcc, s49, v7
    s_nop 0
    s_cbranch_vccnz L_poll_retry_7
    s_branch L_poll_ok_8
L_epoch_9:
    s_mov_b32 s53, 13631488
    buffer_load_dwordx4 v[184:187], v1, s[32:35], s53 offen offset:0 sc1
    buffer_load_dwordx4 v[188:191], v1, s[32:35], s53 offen offset:1024 sc1
    buffer_load_dwordx4 v[192:195], v1, s[32:35], s53 offen offset:2048 sc1
    buffer_load_dwordx4 v[196:199], v1, s[32:35], s53 offen offset:3072 sc1
    s_mov_b32 s53, 13635584
    buffer_load_dwordx4 v[200:203], v1, s[32:35], s53 offen offset:0 sc1
    buffer_load_dwordx4 v[204:207], v1, s[32:35], s53 offen offset:1024 sc1
    buffer_load_dwordx4 v[208:211], v1, s[32:35], s53 offen offset:2048 sc1
    buffer_load_dwordx4 v[212:215], v1, s[32:35], s53 offen offset:3072 sc1
    s_mov_b32 s53, 13639680
    buffer_load_dwordx4 v[216:219], v1, s[32:35], s53 offen offset:0 sc1
    buffer_load_dwordx4 v[220:223], v1, s[32:35], s53 offen offset:1024 sc1
    buffer_load_dwordx4 v[224:227], v1, s[32:35], s53 offen offset:2048 sc1
    buffer_load_dwordx4 v[228:231], v1, s[32:35], s53 offen offset:3072 sc1
    s_mov_b32 s53, 13643776
    buffer_load_dwordx4 v[232:235], v1, s[32:35], s53 offen offset:0 sc1
    buffer_load_dwordx4 v[236:239], v1, s[32:35], s53 offen offset:1024 sc1
    buffer_load_dwordx4 v[240:243], v1, s[32:35], s53 offen offset:2048 sc1
    buffer_load_dwordx4 v[244:247], v1, s[32:35], s53 offen offset:3072 sc1
    s_branch L_noepoch_10
L_ep_retry_14:
    s_sub_u32 s57, s57, 1
    s_cbranch_scc1 L_end
    s_mov_b32 s53, 13631488
    buffer_load_dwordx4 v[184:187], v1, s[32:35], s53 offen offset:0 sc1
    buffer_load_dwordx4 v[188:191], v1, s[32:35], s53 offen offset:1024 sc1
    buffer_load_dwordx4 v[192:195], v1, s[32:35], s53 offen offset:2048 sc1
    buffer_load_dwordx4 v[196:199], v1, s[32:35], s53 offen offset:3072 sc1
    s_mov_b32 s53, 13635584
    buffer_load_dwordx4 v[200:203], v1, s[32:35], s53 offen offset:0 sc1
    buffer_load_dwordx4 v[204:207], v1, s[32:35], s53 offen offset:1024 sc1
    buffer_load_dwordx4 v[208:211], v1, s[32:35], s53 offen offset:2048 sc1
    buffer_load_dwordx4 v[212:215], v1, s[32:35], s53 offen offset:3072 sc1
    s_mov_b32 s53, 13639680
    buffer_load_dwordx4 v[216:219], v1, s[32:35], s53 offen offset:0 sc1
    buffer_load_dwordx4 v[220:223], v1, s[32:35], s53 offen offset:1024 sc1
    buffer_load_dwordx4 v[224:227], v1, s[32:35], s53 offen offset:2048 sc1
    buffer_load_dwordx4 v[228:231], v1, s[32:35], s53 offen offset:3072 sc1
    s_mov_b32 s53, 13643776
    buffer_load_dwordx4 v[232:235], v1, s[32:35], s53 offen offset:0 sc1
    buffer_load_dwordx4 v[236:239], v1, s[32:35], s53 offen offset:1024 sc1
    buffer_load_dwordx4 v[240:243], v1, s[32:35], s53 offen offset:2048 sc1
    buffer_load_dwordx4 v[244:247], v1, s[32:35], s53 offen offset:3072 sc1
    s_waitcnt vmcnt(0)
    v_xor_b32 v34, s49, v185
    v_bitop3_b32 v34, v34, s49, v189 bitop3:0xf6
    v_bitop3_b32 v34, v34, s49, v193 bitop3:0xf6
    v_bitop3_b32 v34, v34, s49, v197 bitop3:0xf6
    v_bitop3_b32 v34, v34, s49, v201 bitop3:0xf6
    v_bitop3_b32 v34, v34, s49, v205 bitop3:0xf6
    v_bitop3_b32 v34, v34, s49, v209 bitop3:0xf6
    v_bitop3_b32 v34, v34, s49, v213 bitop3:0xf6
    v_bitop3_b32 v34, v34, s49, v217 bitop3:0xf6
    v_bitop3_b32 v34, v34, s49, v221 bitop3:0xf6
    v_bitop3_b32 v34, v34, s49, v225 bitop3:0xf6
    v_bitop3_b32 v34, v34, s49, v229 bitop3:0xf6
    v_bitop3_b32 v34, v34, s49, v233 bitop3:0xf6
    v_bitop3_b32 v34, v34, s49, v237 bitop3:0xf6
    v_bitop3_b32 v34, v34, s49, v241 bitop3:0xf6
    v_bitop3_b32 v34, v34, s49, v245 bitop3:0xf6
    v_cmp_ne_u32 vcc, 0, v34
    s_nop 0
    s_cbranch_vccnz L_ep_retry_14
    s_branch L_ep_ok_15
L_epoch_12:
    s_waitcnt vmcnt(0)
    v_xor_b32 v34, s49, v185
    v_bitop3_b32 v34, v34, s49, v189 bitop3:0xf6
    v_bitop3_b32 v34, v34, s49, v193 bitop3:0xf6
    v_bitop3_b32 v34, v34, s49, v197 bitop3:0xf6
    v_bitop3_b32 v34, v34, s49, v201 bitop3:0xf6
    v_bitop3_b32 v34, v34, s49, v205 bitop3:0xf6
    v_bitop3_b32 v34, v34, s49, v209 bitop3:0xf6
    v_bitop3_b32 v34, v34, s49, v213 bitop3:0xf6
    v_bitop3_b32 v34, v34, s49, v217 bitop3:0xf6
    v_bitop3_b32 v34, v34, s49, v221 bitop3:0xf6
    v_bitop3_b32 v34, v34, s49, v225 bitop3:0xf6
    v_bitop3_b32 v34, v34, s49, v229 bitop3:0xf6
    v_bitop3_b32 v34, v34, s49, v233 bitop3:0xf6
    v_bitop3_b32 v34, v34, s49, v237 bitop3:0xf6
    v_bitop3_b32 v34, v34, s49, v241 bitop3:0xf6
    v_bitop3_b32 v34, v34, s49, v245 bitop3:0xf6
    v_cmp_ne_u32 vcc, 0, v34
    s_nop 0
    s_cbranch_vccnz L_ep_retry_14
L_ep_ok_15:
    s_mov_b32 s53, 13778944
    s_mov_b64 exec, 1
    buffer_store_dword v2, off, s[32:35], s53 sc1
    s_mov_b64 exec, -1
    s_branch L_noepoch_13
L_attn_safe_17:
    v_mov_b32 v25, 0xff61b1e6
    v_mov_b32 v23, v25
    v_mov_b32 v24, v25
    v_mov_b32 v80, 0
    v_mov_b32 v81, 0
    v_mov_b32 v82, 0
    v_mov_b32 v83, 0
    v_mov_b32 v84, 0
    v_mov_b32 v85, 0
    v_mov_b32 v86, 0
    v_mov_b32 v87, 0
    v_mov_b32 v88, 0
    v_mov_b32 v89, 0
    v_mov_b32 v90, 0
    v_mov_b32 v91, 0
    v_mov_b32 v92, 0
    v_mov_b32 v93, 0
    v_mov_b32 v94, 0
    v_mov_b32 v95, 0
    v_mov_b32 v96, 0
    v_mov_b32 v97, 0
    v_mov_b32 v98, 0
    v_mov_b32 v99, 0
    v_mov_b32 v100, 0
    v_mov_b32 v101, 0
    v_mov_b32 v102, 0
    v_mov_b32 v103, 0
    v_mov_b32 v104, 0
    v_mov_b32 v105, 0
    v_mov_b32 v106, 0
    v_mov_b32 v107, 0
    v_mov_b32 v108, 0
    v_mov_b32 v109, 0
    v_mov_b32 v110, 0
    v_mov_b32 v111, 0
    v_mfma_f32_32x32x16_bf16 v[128:143], a[164:167], v[60:63], 0
    s_nop 11
    v_cndmask_b32 v128, v25, v128, s[64:65]
    v_cndmask_b32 v129, v25, v129, s[66:67]
    v_cndmask_b32 v130, v25, v130, s[68:69]
    v_cndmask_b32 v131, v25, v131, s[70:71]
    v_cndmask_b32 v132, v25, v132, s[72:73]
    v_cndmask_b32 v133, v25, v133, s[74:75]
    v_cndmask_b32 v134, v25, v134, s[76:77]
    v_cndmask_b32 v135, v25, v135, s[78:79]
    v_cndmask_b32 v136, v25, v136, s[80:81]
    v_cndmask_b32 v137, v25, v137, s[82:83]
    v_cndmask_b32 v138, v25, v138, s[84:85]
    v_cndmask_b32 v139, v25, v139, s[86:87]
    v_cndmask_b32 v140, v25, v140, s[88:89]
    v_cndmask_b32 v141, v25, v141, s[90:91]
    v_cndmask_b32 v142, v25, v142, s[92:93]
    v_cndmask_b32 v143, v25, v143, s[94:95]
    v_max3_f32 v24, v24, v128, v129
    v_max3_f32 v24, v24, v130, v131
    v_max3_f32 v24, v24, v132, v133
    v_max3_f32 v24, v24, v134, v135
    v_max3_f32 v24, v24, v136, v137
    v_max3_f32 v24, v24, v138, v139
    v_max3_f32 v24, v24, v140, v141
    v_max3_f32 v24, v24, v142, v143
    v_mfma_f32_32x32x16_bf16 v[112:127], a[160:163], v[56:59], 0
    v_mfma_f32_32x32x16_bf16 v[128:143], a[160:163], v[60:63], 0
    s_nop 10
    v_cndmask_b32 v112, v25, v112, s[64:65]
    v_cndmask_b32 v113, v25, v113, s[66:67]
    v_cndmask_b32 v114, v25, v114, s[68:69]
    v_cndmask_b32 v115, v25, v115, s[70:71]
    v_cndmask_b32 v116, v25, v116, s[72:73]
    v_cndmask_b32 v117, v25, v117, s[74:75]
    v_cndmask_b32 v118, v25, v118, s[76:77]
    v_cndmask_b32 v119, v25, v119, s[78:79]
    v_cndmask_b32 v120, v25, v120, s[80:81]
    v_cndmask_b32 v121, v25, v121, s[82:83]
    v_cndmask_b32 v122, v25, v122, s[84:85]
    v_cndmask_b32 v123, v25, v123, s[86:87]
    v_cndmask_b32 v124, v25, v124, s[88:89]
    v_cndmask_b32 v125, v25, v125, s[90:91]
    v_cndmask_b32 v126, v25, v126, s[92:93]
    v_cndmask_b32 v127, v25, v127, s[94:95]
    v_max3_f32 v23, v23, v112, v113
    v_max3_f32 v23, v23, v114, v115
    v_max3_f32 v23, v23, v116, v117
    v_max3_f32 v23, v23, v118, v119
    v_max3_f32 v23, v23, v120, v121
    v_max3_f32 v23, v23, v122, v123
    v_max3_f32 v23, v23, v124, v125
    v_max3_f32 v23, v23, v126, v127
    v_max3_f32 v24, v24, v128, v129
    v_max3_f32 v24, v24, v130, v131
    v_max3_f32 v24, v24, v132, v133
    v_max3_f32 v24, v24, v134, v135
    v_max3_f32 v24, v24, v136, v137
    v_max3_f32 v24, v24, v138, v139
    v_max3_f32 v24, v24, v140, v141
    v_max3_f32 v24, v24, v142, v143
    s_nop 1
    s_cmp_eq_u32 s58, 0
    s_cbranch_scc1 L_sdone_18
    v_mfma_f32_32x32x16_bf16 v[112:127], a[156:159], v[56:59], 0
    v_mfma_f32_32x32x16_bf16 v[128:143], a[156:159], v[60:63], 0
    s_nop 10
    v_max3_f32 v23, v23, v112, v113
    v_max3_f32 v23, v23, v114, v115
    v_max3_f32 v23, v23, v116, v117
    v_max3_f32 v23, v23, v118, v119
    v_max3_f32 v23, v23, v120, v121
    v_max3_f32 v23, v23, v122, v123
    v_max3_f32 v23, v23, v124, v125
    v_max3_f32 v23, v23, v126, v127
    v_max3_f32 v24, v24, v128, v129
    v_max3_f32 v24, v24, v130, v131
    v_max3_f32 v24, v24, v132, v133
    v_max3_f32 v24, v24, v134, v135
    v_max3_f32 v24, v24, v136, v137
    v_max3_f32 v24, v24, v138, v139
    v_max3_f32 v24, v24, v140, v141
    v_max3_f32 v24, v24, v142, v143
    v_mfma_f32_32x32x16_bf16 v[112:127], a[152:155], v[56:59], 0
    v_mfma_f32_32x32x16_bf16 v[128:143], a[152:155], v[60:63], 0
    s_nop 10
    v_max3_f32 v23, v23, v112, v113
    v_max3_f32 v23, v23, v114, v115
    v_max3_f32 v23, v23, v116, v117
    v_max3_f32 v23, v23, v118, v119
    v_max3_f32 v23, v23, v120, v121
    v_max3_f32 v23, v23, v122, v123
    v_max3_f32 v23, v23, v124, v125
    v_max3_f32 v23, v23, v126, v127
    v_max3_f32 v24, v24, v128, v129
    v_max3_f32 v24, v24, v130, v131
    v_max3_f32 v24, v24, v132, v133
    v_max3_f32 v24, v24, v134, v135
    v_max3_f32 v24, v24, v136, v137
    v_max3_f32 v24, v24, v138, v139
    v_max3_f32 v24, v24, v140, v141
    v_max3_f32 v24, v24, v142, v143
    s_nop 1
    s_cmp_eq_u32 s58, 2
    s_cbranch_scc1 L_sdone_18
    v_mfma_f32_32x32x16_bf16 v[112:127], a[148:151], v[56:59], 0
    v_mfma_f32_32x32x16_bf16 v[128:143], a[148:151], v[60:63], 0
    s_nop 10
    v_max3_f32 v23, v23, v112, v113
    v_max3_f32 v23, v23, v114, v115
    v_max3_f32 v23, v23, v116, v117
    v_max3_f32 v23, v23, v118, v119
    v_max3_f32 v23, v23, v120, v121
    v_max3_f32 v23, v23, v122, v123
    v_max3_f32 v23, v23, v124, v125
    v_max3_f32 v23, v23, v126, v127
    v_max3_f32 v24, v24, v128, v129
    v_max3_f32 v24, v24, v130, v131
    v_max3_f32 v24, v24, v132, v133
    v_max3_f32 v24, v24, v134, v135
    v_max3_f32 v24, v24, v136, v137
    v_max3_f32 v24, v24, v138, v139
    v_max3_f32 v24, v24, v140, v141
    v_max3_f32 v24, v24, v142, v143
    v_mfma_f32_32x32x16_bf16 v[112:127], a[144:147], v[56:59], 0
    v_mfma_f32_32x32x16_bf16 v[128:143], a[144:147], v[60:63], 0
    s_nop 10
    v_max3_f32 v23, v23, v112, v113
    v_max3_f32 v23, v23, v114, v115
    v_max3_f32 v23, v23, v116, v117
    v_max3_f32 v23, v23, v118, v119
    v_max3_f32 v23, v23, v120, v121
    v_max3_f32 v23, v23, v122, v123
    v_max3_f32 v23, v23, v124, v125
    v_max3_f32 v23, v23, v126, v127
    v_max3_f32 v24, v24, v128, v129
    v_max3_f32 v24, v24, v130, v131
    v_max3_f32 v24, v24, v132, v133
    v_max3_f32 v24, v24, v134, v135
    v_max3_f32 v24, v24, v136, v137
    v_max3_f32 v24, v24, v138, v139
    v_max3_f32 v24, v24, v140, v141
    v_max3_f32 v24, v24, v142, v143
    s_nop 1
    s_cmp_eq_u32 s58, 4
    s_cbranch_scc1 L_sdone_18
    v_mfma_f32_32x32x16_bf16 v[112:127], a[140:143], v[56:59], 0
    v_mfma_f32_32x32x16_bf16 v[128:143], a[140:143], v[60:63], 0
    s_nop 10
    v_max3_f32 v23, v23, v112, v113
    v_max3_f32 v23, v23, v114, v115
    v_max3_f32 v23, v23, v116, v117
    v_max3_f32 v23, v23, v118, v119
    v_max3_f32 v23, v23, v120, v121
    v_max3_f32 v23, v23, v122, v123
    v_max3_f32 v23, v23, v124, v125
    v_max3_f32 v23, v23, v126, v127
    v_max3_f32 v24, v24, v128, v129
    v_max3_f32 v24, v24, v130, v131
    v_max3_f32 v24, v24, v132, v133
    v_max3_f32 v24, v24, v134, v135
    v_max3_f32 v24, v24, v136, v137
    v_max3_f32 v24, v24, v138, v139
    v_max3_f32 v24, v24, v140, v141
    v_max3_f32 v24, v24, v142, v143
    v_mfma_f32_32x32x16_bf16 v[112:127], a[136:139], v[56:59], 0
    v_mfma_f32_32x32x16_bf16 v[128:143], a[136:139], v[60:63], 0
    s_nop 10
    v_max3_f32 v23, v23, v112, v113
    v_max3_f32 v23, v23, v114, v115
    v_max3_f32 v23, v23, v116, v117
    v_max3_f32 v23, v23, v118, v119
    v_max3_f32 v23, v23, v120, v121
    v_max3_f32 v23, v23, v122, v123
    v_max3_f32 v23, v23, v124, v125
    v_max3_f32 v23, v23, v126, v127
    v_max3_f32 v24, v24, v128, v129
    v_max3_f32 v24, v24, v130, v131
    v_max3_f32 v24, v24, v132, v133
    v_max3_f32 v24, v24, v134, v135
    v_max3_f32 v24, v24, v136, v137
    v_max3_f32 v24, v24, v138, v139
    v_max3_f32 v24, v24, v140, v141
    v_max3_f32 v24, v24, v142, v143
    s_nop 1
    s_cmp_eq_u32 s58, 6
    s_cbranch_scc1 L_sdone_18
    v_mfma_f32_32x32x16_bf16 v[112:127], a[132:135], v[56:59], 0
    v_mfma_f32_32x32x16_bf16 v[128:143], a[132:135], v[60:63], 0
    s_nop 10
    v_max3_f32 v23, v23, v112, v113
    v_max3_f32 v23, v23, v114, v115
    v_max3_f32 v23, v23, v116, v117
    v_max3_f32 v23, v23, v118, v119
    v_max3_f32 v23, v23, v120, v121
    v_max3_f32 v23, v23, v122, v123
    v_max3_f32 v23, v23, v124, v125
    v_max3_f32 v23, v23, v126, v127
    v_cndmask_b32 v128, v128, v25, s[64:65]
    v_cndmask_b32 v129, v129, v25, s[66:67]
    v_cndmask_b32 v130, v130, v25, s[68:69]
    v_cndmask_b32 v131, v131, v25, s[70:71]
    v_cndmask_b32 v132, v132, v25, s[72:73]
    v_cndmask_b32 v133, v133, v25, s[74:75]
    v_cndmask_b32 v134, v134, v25, s[76:77]
    v_cndmask_b32 v135, v135, v25, s[78:79]
    v_cndmask_b32 v136, v136, v25, s[80:81]
    v_cndmask_b32 v137, v137, v25, s[82:83]
    v_cndmask_b32 v138, v138, v25, s[84:85]
    v_cndmask_b32 v139, v139, v25, s[86:87]
    v_cndmask_b32 v140, v140, v25, s[88:89]
    v_cndmask_b32 v141, v141, v25, s[90:91]
    v_cndmask_b32 v142, v142, v25, s[92:93]
    v_cndmask_b32 v143, v143, v25, s[94:95]
    v_max3_f32 v24, v24, v128, v129
    v_max3_f32 v24, v24, v130, v131
    v_max3_f32 v24, v24, v132, v133
    v_max3_f32 v24, v24, v134, v135
    v_max3_f32 v24, v24, v136, v137
    v_max3_f32 v24, v24, v138, v139
    v_max3_f32 v24, v24, v140, v141
    v_max3_f32 v24, v24, v142, v143
    v_mfma_f32_32x32x16_bf16 v[112:127], a[128:131], v[56:59], 0
    s_nop 11
    v_cndmask_b32 v112, v112, v25, s[64:65]
    v_cndmask_b32 v113, v113, v25, s[66:67]
    v_cndmask_b32 v114, v114, v25, s[68:69]
    v_cndmask_b32 v115, v115, v25, s[70:71]
    v_cndmask_b32 v116, v116, v25, s[72:73]
    v_cndmask_b32 v117, v117, v25, s[74:75]
    v_cndmask_b32 v118, v118, v25, s[76:77]
    v_cndmask_b32 v119, v119, v25, s[78:79]
    v_cndmask_b32 v120, v120, v25, s[80:81]
    v_cndmask_b32 v121, v121, v25, s[82:83]
    v_cndmask_b32 v122, v122, v25, s[84:85]
    v_cndmask_b32 v123, v123, v25, s[86:87]
    v_cndmask_b32 v124, v124, v25, s[88:89]
    v_cndmask_b32 v125, v125, v25, s[90:91]
    v_cndmask_b32 v126, v126, v25, s[92:93]
    v_cndmask_b32 v127, v127, v25, s[94:95]
    v_max3_f32 v23, v23, v112, v113
    v_max3_f32 v23, v23, v114, v115
    v_max3_f32 v23, v23, v116, v117
    v_max3_f32 v23, v23, v118, v119
    v_max3_f32 v23, v23, v120, v121
    v_max3_f32 v23, v23, v122, v123
    v_max3_f32 v23, v23, v124, v125
    v_max3_f32 v23, v23, v126, v127
    s_nop 1
L_sdone_18:
    v_mov_b32 v26, v23
    v_mov_b32 v27, v24
    s_nop 0
    v_permlane32_swap_b32 v23, v26
    v_permlane32_swap_b32 v24, v27
    v_max_f32 v23, v23, v26
    v_max_f32 v24, v24, v27
    v_mfma_f32_32x32x16_bf16 v[128:143], a[164:167], v[60:63], 0
    s_nop 11
    v_sub_f32 v128, v128, v24
    v_sub_f32 v129, v129, v24
    v_sub_f32 v130, v130, v24
    v_sub_f32 v131, v131, v24
    v_sub_f32 v132, v132, v24
    v_sub_f32 v133, v133, v24
    v_sub_f32 v134, v134, v24
    v_sub_f32 v135, v135, v24
    v_sub_f32 v136, v136, v24
    v_sub_f32 v137, v137, v24
    v_sub_f32 v138, v138, v24
    v_sub_f32 v139, v139, v24
    v_sub_f32 v140, v140, v24
    v_sub_f32 v141, v141, v24
    v_sub_f32 v142, v142, v24
    v_sub_f32 v143, v143, v24
    v_cndmask_b32 v128, v25, v128, s[64:65]
    v_cndmask_b32 v129, v25, v129, s[66:67]
    v_cndmask_b32 v130, v25, v130, s[68:69]
    v_cndmask_b32 v131, v25, v131, s[70:71]
    v_cndmask_b32 v132, v25, v132, s[72:73]
    v_cndmask_b32 v133, v25, v133, s[74:75]
    v_cndmask_b32 v134, v25, v134, s[76:77]
    v_cndmask_b32 v135, v25, v135, s[78:79]
    v_cndmask_b32 v136, v25, v136, s[80:81]
    v_cndmask_b32 v137, v25, v137, s[82:83]
    v_cndmask_b32 v138, v25, v138, s[84:85]
    v_cndmask_b32 v139, v25, v139, s[86:87]
    v_cndmask_b32 v140, v25, v140, s[88:89]
    v_cndmask_b32 v141, v25, v141, s[90:91]
    v_cndmask_b32 v142, v25, v142, s[92:93]
    v_cndmask_b32 v143, v25, v143, s[94:95]
    v_exp_f32 v128, v128
    v_exp_f32 v129, v129
    v_exp_f32 v130, v130
    v_exp_f32 v131, v131
    v_exp_f32 v132, v132
    v_exp_f32 v133, v133
    v_exp_f32 v134, v134
    v_exp_f32 v135, v135
    v_cvt_pk_bf16_f32 v168, v128, v129
    v_cvt_pk_bf16_f32 v169, v130, v131
    v_exp_f32 v136, v136
    v_exp_f32 v137, v137
    v_exp_f32 v138, v138
    v_exp_f32 v139, v139
    v_cvt_pk_bf16_f32 v170, v132, v133
    v_cvt_pk_bf16_f32 v171, v134, v135
    v_exp_f32 v140, v140
    v_exp_f32 v141, v141
    v_exp_f32 v142, v142
    v_exp_f32 v143, v143
    v_cvt_pk_bf16_f32 v172, v136, v137
    v_cvt_pk_bf16_f32 v173, v138, v139
    v_cvt_pk_bf16_f32 v174, v140, v141
    v_cvt_pk_bf16_f32 v175, v142, v143
    v_mfma_f32_32x32x16_bf16 v[96:111], a[240:243], v[168:171], v[96:111]
    s_nop 0
    v_mfma_f32_32x32x16_bf16 v[96:111], a[244:247], v[172:175], v[96:111]
    v_mfma_f32_32x32x16_bf16 v[112:127], a[160:163], v[56:59], 0
    v_mfma_f32_32x32x16_bf16 v[128:143], a[160:163], v[60:63], 0
    s_nop 10
    v_sub_f32 v112, v112, v23
    v_sub_f32 v113, v113, v23
    v_sub_f32 v114, v114, v23
    v_sub_f32 v115, v115, v23
    v_sub_f32 v116, v116, v23
    v_sub_f32 v117, v117, v23
    v_sub_f32 v118, v118, v23
    v_sub_f32 v119, v119, v23
    v_sub_f32 v120, v120, v23
    v_sub_f32 v121, v121, v23
    v_sub_f32 v122, v122, v23
    v_sub_f32 v123, v123, v23
    v_sub_f32 v124, v124, v23
    v_sub_f32 v125, v125, v23
    v_sub_f32 v126, v126, v23
    v_sub_f32 v127, v127, v23
    v_cndmask_b32 v112, v25, v112, s[64:65]
    v_cndmask_b32 v113, v25, v113, s[66:67]
    v_cndmask_b32 v114, v25, v114, s[68:69]
    v_cndmask_b32 v115, v25, v115, s[70:71]
    v_cndmask_b32 v116, v25, v116, s[72:73]
    v_cndmask_b32 v117, v25, v117, s[74:75]
    v_cndmask_b32 v118, v25, v118, s[76:77]
    v_cndmask_b32 v119, v25, v119, s[78:79]
    v_cndmask_b32 v120, v25, v120, s[80:81]
    v_cndmask_b32 v121, v25, v121, s[82:83]
    v_cndmask_b32 v122, v25, v122, s[84:85]
    v_cndmask_b32 v123, v25, v123, s[86:87]
    v_cndmask_b32 v124, v25, v124, s[88:89]
    v_cndmask_b32 v125, v25, v125, s[90:91]
    v_cndmask_b32 v126, v25, v126, s[92:93]
    v_cndmask_b32 v127, v25, v127, s[94:95]
    v_exp_f32 v112, v112
    v_exp_f32 v113, v113
    v_exp_f32 v114, v114
    v_exp_f32 v115, v115
    v_exp_f32 v116, v116
    v_exp_f32 v117, v117
    v_exp_f32 v118, v118
    v_exp_f32 v119, v119
    v_cvt_pk_bf16_f32 v160, v112, v113
    v_cvt_pk_bf16_f32 v161, v114, v115
    v_exp_f32 v120, v120
    v_exp_f32 v121, v121
    v_exp_f32 v122, v122
    v_exp_f32 v123, v123
    v_cvt_pk_bf16_f32 v162, v116, v117
    v_cvt_pk_bf16_f32 v163, v118, v119
    v_exp_f32 v124, v124
    v_exp_f32 v125, v125
    v_exp_f32 v126, v126
    v_exp_f32 v127, v127
    v_cvt_pk_bf16_f32 v164, v120, v121
    v_cvt_pk_bf16_f32 v165, v122, v123
    v_cvt_pk_bf16_f32 v166, v124, v125
    v_cvt_pk_bf16_f32 v167, v126, v127
    v_mfma_f32_32x32x16_bf16 v[80:95], a[232:235], v[160:163], v[80:95]
    s_nop 0
    v_mfma_f32_32x32x16_bf16 v[80:95], a[236:239], v[164:167], v[80:95]
    v_sub_f32 v128, v128, v24
    v_sub_f32 v129, v129, v24
    v_sub_f32 v130, v130, v24
    v_sub_f32 v131, v131, v24
    v_sub_f32 v132, v132, v24
    v_sub_f32 v133, v133, v24
    v_sub_f32 v134, v134, v24
    v_sub_f32 v135, v135, v24
    v_sub_f32 v136, v136, v24
    v_sub_f32 v137, v137, v24
    v_sub_f32 v138, v138, v24
    v_sub_f32 v139, v139, v24
    v_sub_f32 v140, v140, v24
    v_sub_f32 v141, v141, v24
    v_sub_f32 v142, v142, v24
    v_sub_f32 v143, v143, v24
    v_exp_f32 v128, v128
    v_exp_f32 v129, v129
    v_exp_f32 v130, v130
    v_exp_f32 v131, v131
    v_exp_f32 v132, v132
    v_exp_f32 v133, v133
    v_exp_f32 v134, v134
    v_exp_f32 v135, v135
    v_cvt_pk_bf16_f32 v168, v128, v129
    v_cvt_pk_bf16_f32 v169, v130, v131
    v_exp_f32 v136, v136
    v_exp_f32 v137, v137
    v_exp_f32 v138, v138
    v_exp_f32 v139, v139
    v_cvt_pk_bf16_f32 v170, v132, v133
    v_cvt_pk_bf16_f32 v171, v134, v135
    v_exp_f32 v140, v140
    v_exp_f32 v141, v141
    v_exp_f32 v142, v142
    v_exp_f32 v143, v143
    v_cvt_pk_bf16_f32 v172, v136, v137
    v_cvt_pk_bf16_f32 v173, v138, v139
    v_cvt_pk_bf16_f32 v174, v140, v141
    v_cvt_pk_bf16_f32 v175, v142, v143
    v_mfma_f32_32x32x16_bf16 v[96:111], a[232:235], v[168:171], v[96:111]
    s_nop 0
    v_mfma_f32_32x32x16_bf16 v[96:111], a[236:239], v[172:175], v[96:111]
    s_nop 11
    s_cmp_eq_u32 s58, 0
    s_cbranch_scc1 L_sdone_19
    v_mfma_f32_32x32x16_bf16 v[112:127], a[156:159], v[56:59], 0
    v_mfma_f32_32x32x16_bf16 v[128:143], a[156:159], v[60:63], 0
    s_nop 10
    v_sub_f32 v112, v112, v23
    v_sub_f32 v113, v113, v23
    v_sub_f32 v114, v114, v23
    v_sub_f32 v115, v115, v23
    v_sub_f32 v116, v116, v23
    v_sub_f32 v117, v117, v23
    v_sub_f32 v118, v118, v23
    v_sub_f32 v119, v119, v23
    v_sub_f32 v120, v120, v23
    v_sub_f32 v121, v121, v23
    v_sub_f32 v122, v122, v23
    v_sub_f32 v123, v123, v23
    v_sub_f32 v124, v124, v23
    v_sub_f32 v125, v125, v23
    v_sub_f32 v126, v126, v23
    v_sub_f32 v127, v127, v23
    v_exp_f32 v112, v112
    v_exp_f32 v113, v113
    v_exp_f32 v114, v114
    v_exp_f32 v115, v115
    v_exp_f32 v116, v116
    v_exp_f32 v117, v117
    v_exp_f32 v118, v118
    v_exp_f32 v119, v119
    v_cvt_pk_bf16_f32 v160, v112, v113
    v_cvt_pk_bf16_f32 v161, v114, v115
    v_exp_f32 v120, v120
    v_exp_f32 v121, v121
    v_exp_f32 v122, v122
    v_exp_f32 v123, v123
    v_cvt_pk_bf16_f32 v162, v116, v117
    v_cvt_pk_bf16_f32 v163, v118, v119
    v_exp_f32 v124, v124
    v_exp_f32 v125, v125
    v_exp_f32 v126, v126
    v_exp_f32 v127, v127
    v_cvt_pk_bf16_f32 v164, v120, v121
    v_cvt_pk_bf16_f32 v165, v122, v123
    v_cvt_pk_bf16_f32 v166, v124, v125
    v_cvt_pk_bf16_f32 v167, v126, v127
    v_mfma_f32_32x32x16_bf16 v[80:95], a[224:227], v[160:163], v[80:95]
    s_nop 0
    v_mfma_f32_32x32x16_bf16 v[80:95], a[228:231], v[164:167], v[80:95]
    v_sub_f32 v128, v128, v24
    v_sub_f32 v129, v129, v24
    v_sub_f32 v130, v130, v24
    v_sub_f32 v131, v131, v24
    v_sub_f32 v132, v132, v24
    v_sub_f32 v133, v133, v24
    v_sub_f32 v134, v134, v24
    v_sub_f32 v135, v135, v24
    v_sub_f32 v136, v136, v24
    v_sub_f32 v137, v137, v24
    v_sub_f32 v138, v138, v24
    v_sub_f32 v139, v139, v24
    v_sub_f32 v140, v140, v24
    v_sub_f32 v141, v141, v24
    v_sub_f32 v142, v142, v24
    v_sub_f32 v143, v143, v24
    v_exp_f32 v128, v128
    v_exp_f32 v129, v129
    v_exp_f32 v130, v130
    v_exp_f32 v131, v131
    v_exp_f32 v132, v132
    v_exp_f32 v133, v133
    v_exp_f32 v134, v134
    v_exp_f32 v135, v135
    v_cvt_pk_bf16_f32 v168, v128, v129
    v_cvt_pk_bf16_f32 v169, v130, v131
    v_exp_f32 v136, v136
    v_exp_f32 v137, v137
    v_exp_f32 v138, v138
    v_exp_f32 v139, v139
    v_cvt_pk_bf16_f32 v170, v132, v133
    v_cvt_pk_bf16_f32 v171, v134, v135
    v_exp_f32 v140, v140
    v_exp_f32 v141, v141
    v_exp_f32 v142, v142
    v_exp_f32 v143, v143
    v_cvt_pk_bf16_f32 v172, v136, v137
    v_cvt_pk_bf16_f32 v173, v138, v139
    v_cvt_pk_bf16_f32 v174, v140, v141
    v_cvt_pk_bf16_f32 v175, v142, v143
    v_mfma_f32_32x32x16_bf16 v[96:111], a[224:227], v[168:171], v[96:111]
    s_nop 0
    v_mfma_f32_32x32x16_bf16 v[96:111], a[228:231], v[172:175], v[96:111]
    v_mfma_f32_32x32x16_bf16 v[112:127], a[152:155], v[56:59], 0
    v_mfma_f32_32x32x16_bf16 v[128:143], a[152:155], v[60:63], 0
    s_nop 10
    v_sub_f32 v112, v112, v23
    v_sub_f32 v113, v113, v23
    v_sub_f32 v114, v114, v23
    v_sub_f32 v115, v115, v23
    v_sub_f32 v116, v116, v23
    v_sub_f32 v117, v117, v23
    v_sub_f32 v118, v118, v23
    v_sub_f32 v119, v119, v23
    v_sub_f32 v120, v120, v23
    v_sub_f32 v121, v121, v23
    v_sub_f32 v122, v122, v23
    v_sub_f32 v123, v123, v23
    v_sub_f32 v124, v124, v23
    v_sub_f32 v125, v125, v23
    v_sub_f32 v126, v126, v23
    v_sub_f32 v127, v127, v23
    v_exp_f32 v112, v112
    v_exp_f32 v113, v113
    v_exp_f32 v114, v114
    v_exp_f32 v115, v115
    v_exp_f32 v116, v116
    v_exp_f32 v117, v117
    v_exp_f32 v118, v118
    v_exp_f32 v119, v119
    v_cvt_pk_bf16_f32 v160, v112, v113
    v_cvt_pk_bf16_f32 v161, v114, v115
    v_exp_f32 v120, v120
    v_exp_f32 v121, v121
    v_exp_f32 v122, v122
    v_exp_f32 v123, v123
    v_cvt_pk_bf16_f32 v162, v116, v117
    v_cvt_pk_bf16_f32 v163, v118, v119
    v_exp_f32 v124, v124
    v_exp_f32 v125, v125
    v_exp_f32 v126, v126
    v_exp_f32 v127, v127
    v_cvt_pk_bf16_f32 v164, v120, v121
    v_cvt_pk_bf16_f32 v165, v122, v123
    v_cvt_pk_bf16_f32 v166, v124, v125
    v_cvt_pk_bf16_f32 v167, v126, v127
    v_mfma_f32_32x32x16_bf16 v[80:95], a[216:219], v[160:163], v[80:95]
    s_nop 0
    v_mfma_f32_32x32x16_bf16 v[80:95], a[220:223], v[164:167], v[80:95]
    v_sub_f32 v128, v128, v24
    v_sub_f32 v129, v129, v24
    v_sub_f32 v130, v130, v24
    v_sub_f32 v131, v131, v24
    v_sub_f32 v132, v132, v24
    v_sub_f32 v133, v133, v24
    v_sub_f32 v134, v134, v24
    v_sub_f32 v135, v135, v24
    v_sub_f32 v136, v136, v24
    v_sub_f32 v137, v137, v24
    v_sub_f32 v138, v138, v24
    v_sub_f32 v139, v139, v24
    v_sub_f32 v140, v140, v24
    v_sub_f32 v141, v141, v24
    v_sub_f32 v142, v142, v24
    v_sub_f32 v143, v143, v24
    v_exp_f32 v128, v128
    v_exp_f32 v129, v129
    v_exp_f32 v130, v130
    v_exp_f32 v131, v131
    v_exp_f32 v132, v132
    v_exp_f32 v133, v133
    v_exp_f32 v134, v134
    v_exp_f32 v135, v135
    v_cvt_pk_bf16_f32 v168, v128, v129
    v_cvt_pk_bf16_f32 v169, v130, v131
    v_exp_f32 v136, v136
    v_exp_f32 v137, v137
    v_exp_f32 v138, v138
    v_exp_f32 v139, v139
    v_cvt_pk_bf16_f32 v170, v132, v133
    v_cvt_pk_bf16_f32 v171, v134, v135
    v_exp_f32 v140, v140
    v_exp_f32 v141, v141
    v_exp_f32 v142, v142
    v_exp_f32 v143, v143
    v_cvt_pk_bf16_f32 v172, v136, v137
    v_cvt_pk_bf16_f32 v173, v138, v139
    v_cvt_pk_bf16_f32 v174, v140, v141
    v_cvt_pk_bf16_f32 v175, v142, v143
    v_mfma_f32_32x32x16_bf16 v[96:111], a[216:219], v[168:171], v[96:111]
    s_nop 0
    v_mfma_f32_32x32x16_bf16 v[96:111], a[220:223], v[172:175], v[96:111]
    s_nop 11
    s_cmp_eq_u32 s58, 2
    s_cbranch_scc1 L_sdone_19
    v_mfma_f32_32x32x16_bf16 v[112:127], a[148:151], v[56:59], 0
    v_mfma_f32_32x32x16_bf16 v[128:143], a[148:151], v[60:63], 0
    s_nop 10
    v_sub_f32 v112, v112, v23
    v_sub_f32 v113, v113, v23
    v_sub_f32 v114, v114, v23
    v_sub_f32 v115, v115, v23
    v_sub_f32 v116, v116, v23
    v_sub_f32 v117, v117, v23
    v_sub_f32 v118, v118, v23
    v_sub_f32 v119, v119, v23
    v_sub_f32 v120, v120, v23
    v_sub_f32 v121, v121, v23
    v_sub_f32 v122, v122, v23
    v_sub_f32 v123, v123, v23
    v_sub_f32 v124, v124, v23
    v_sub_f32 v125, v125, v23
    v_sub_f32 v126, v126, v23
    v_sub_f32 v127, v127, v23
    v_exp_f32 v112, v112
    v_exp_f32 v113, v113
    v_exp_f32 v114, v114
    v_exp_f32 v115, v115
    v_exp_f32 v116, v116
    v_exp_f32 v117, v117
    v_exp_f32 v118, v118
    v_exp_f32 v119, v119
    v_cvt_pk_bf16_f32 v160, v112, v113
    v_cvt_pk_bf16_f32 v161, v114, v115
    v_exp_f32 v120, v120
    v_exp_f32 v121, v121
    v_exp_f32 v122, v122
    v_exp_f32 v123, v123
    v_cvt_pk_bf16_f32 v162, v116, v117
    v_cvt_pk_bf16_f32 v163, v118, v119
    v_exp_f32 v124, v124
    v_exp_f32 v125, v125
    v_exp_f32 v126, v126
    v_exp_f32 v127, v127
    v_cvt_pk_bf16_f32 v164, v120, v121
    v_cvt_pk_bf16_f32 v165, v122, v123
    v_cvt_pk_bf16_f32 v166, v124, v125
    v_cvt_pk_bf16_f32 v167, v126, v127
    v_mfma_f32_32x32x16_bf16 v[80:95], a[208:211], v[160:163], v[80:95]
    s_nop 0
    v_mfma_f32_32x32x16_bf16 v[80:95], a[212:215], v[164:167], v[80:95]
    v_sub_f32 v128, v128, v24
    v_sub_f32 v129, v129, v24
    v_sub_f32 v130, v130, v24
    v_sub_f32 v131, v131, v24
    v_sub_f32 v132, v132, v24
    v_sub_f32 v133, v133, v24
    v_sub_f32 v134, v134, v24
    v_sub_f32 v135, v135, v24
    v_sub_f32 v136, v136, v24
    v_sub_f32 v137, v137, v24
    v_sub_f32 v138, v138, v24
    v_sub_f32 v139, v139, v24
    v_sub_f32 v140, v140, v24
    v_sub_f32 v141, v141, v24
    v_sub_f32 v142, v142, v24
    v_sub_f32 v143, v143, v24
    v_exp_f32 v128, v128
    v_exp_f32 v129, v129
    v_exp_f32 v130, v130
    v_exp_f32 v131, v131
    v_exp_f32 v132, v132
    v_exp_f32 v133, v133
    v_exp_f32 v134, v134
    v_exp_f32 v135, v135
    v_cvt_pk_bf16_f32 v168, v128, v129
    v_cvt_pk_bf16_f32 v169, v130, v131
    v_exp_f32 v136, v136
    v_exp_f32 v137, v137
    v_exp_f32 v138, v138
    v_exp_f32 v139, v139
    v_cvt_pk_bf16_f32 v170, v132, v133
    v_cvt_pk_bf16_f32 v171, v134, v135
    v_exp_f32 v140, v140
    v_exp_f32 v141, v141
    v_exp_f32 v142, v142
    v_exp_f32 v143, v143
    v_cvt_pk_bf16_f32 v172, v136, v137
    v_cvt_pk_bf16_f32 v173, v138, v139
    v_cvt_pk_bf16_f32 v174, v140, v141
    v_cvt_pk_bf16_f32 v175, v142, v143
    v_mfma_f32_32x32x16_bf16 v[96:111], a[208:211], v[168:171], v[96:111]
    s_nop 0
    v_mfma_f32_32x32x16_bf16 v[96:111], a[212:215], v[172:175], v[96:111]
    v_mfma_f32_32x32x16_bf16 v[112:127], a[144:147], v[56:59], 0
    v_mfma_f32_32x32x16_bf16 v[128:143], a[144:147], v[60:63], 0
    s_nop 10
    v_sub_f32 v112, v112, v23
    v_sub_f32 v113, v113, v23
    v_sub_f32 v114, v114, v23
    v_sub_f32 v115, v115, v23
    v_sub_f32 v116, v116, v23
    v_sub_f32 v117, v117, v23
    v_sub_f32 v118, v118, v23
    v_sub_f32 v119, v119, v23
    v_sub_f32 v120, v120, v23
    v_sub_f32 v121, v121, v23
    v_sub_f32 v122, v122, v23
    v_sub_f32 v123, v123, v23
    v_sub_f32 v124, v124, v23
    v_sub_f32 v125, v125, v23
    v_sub_f32 v126, v126, v23
    v_sub_f32 v127, v127, v23
    v_exp_f32 v112, v112
    v_exp_f32 v113, v113
    v_exp_f32 v114, v114
    v_exp_f32 v115, v115
    v_exp_f32 v116, v116
    v_exp_f32 v117, v117
    v_exp_f32 v118, v118
    v_exp_f32 v119, v119
    v_cvt_pk_bf16_f32 v160, v112, v113
    v_cvt_pk_bf16_f32 v161, v114, v115
    v_exp_f32 v120, v120
    v_exp_f32 v121, v121
    v_exp_f32 v122, v122
    v_exp_f32 v123, v123
    v_cvt_pk_bf16_f32 v162, v116, v117
    v_cvt_pk_bf16_f32 v163, v118, v119
    v_exp_f32 v124, v124
    v_exp_f32 v125, v125
    v_exp_f32 v126, v126
    v_exp_f32 v127, v127
    v_cvt_pk_bf16_f32 v164, v120, v121
    v_cvt_pk_bf16_f32 v165, v122, v123
    v_cvt_pk_bf16_f32 v166, v124, v125
    v_cvt_pk_bf16_f32 v167, v126, v127
    v_mfma_f32_32x32x16_bf16 v[80:95], a[200:203], v[160:163], v[80:95]
    s_nop 0
    v_mfma_f32_32x32x16_bf16 v[80:95], a[204:207], v[164:167], v[80:95]
    v_sub_f32 v128, v128, v24
    v_sub_f32 v129, v129, v24
    v_sub_f32 v130, v130, v24
    v_sub_f32 v131, v131, v24
    v_sub_f32 v132, v132, v24
    v_sub_f32 v133, v133, v24
    v_sub_f32 v134, v134, v24
    v_sub_f32 v135, v135, v24
    v_sub_f32 v136, v136, v24
    v_sub_f32 v137, v137, v24
    v_sub_f32 v138, v138, v24
    v_sub_f32 v139, v139, v24
    v_sub_f32 v140, v140, v24
    v_sub_f32 v141, v141, v24
    v_sub_f32 v142, v142, v24
    v_sub_f32 v143, v143, v24
    v_exp_f32 v128, v128
    v_exp_f32 v129, v129
    v_exp_f32 v130, v130
    v_exp_f32 v131, v131
    v_exp_f32 v132, v132
    v_exp_f32 v133, v133
    v_exp_f32 v134, v134
    v_exp_f32 v135, v135
    v_cvt_pk_bf16_f32 v168, v128, v129
    v_cvt_pk_bf16_f32 v169, v130, v131
    v_exp_f32 v136, v136
    v_exp_f32 v137, v137
    v_exp_f32 v138, v138
    v_exp_f32 v139, v139
    v_cvt_pk_bf16_f32 v170, v132, v133
    v_cvt_pk_bf16_f32 v171, v134, v135
    v_exp_f32 v140, v140
    v_exp_f32 v141, v141
    v_exp_f32 v142, v142
    v_exp_f32 v143, v143
    v_cvt_pk_bf16_f32 v172, v136, v137
    v_cvt_pk_bf16_f32 v173, v138, v139
    v_cvt_pk_bf16_f32 v174, v140, v141
    v_cvt_pk_bf16_f32 v175, v142, v143
    v_mfma_f32_32x32x16_bf16 v[96:111], a[200:203], v[168:171], v[96:111]
    s_nop 0
    v_mfma_f32_32x32x16_bf16 v[96:111], a[204:207], v[172:175], v[96:111]
    s_nop 11
    s_cmp_eq_u32 s58, 4
    s_cbranch_scc1 L_sdone_19
    v_mfma_f32_32x32x16_bf16 v[112:127], a[140:143], v[56:59], 0
    v_mfma_f32_32x32x16_bf16 v[128:143], a[140:143], v[60:63], 0
    s_nop 10
    v_sub_f32 v112, v112, v23
    v_sub_f32 v113, v113, v23
    v_sub_f32 v114, v114, v23
    v_sub_f32 v115, v115, v23
    v_sub_f32 v116, v116, v23
    v_sub_f32 v117, v117, v23
    v_sub_f32 v118, v118, v23
    v_sub_f32 v119, v119, v23
    v_sub_f32 v120, v120, v23
    v_sub_f32 v121, v121, v23
    v_sub_f32 v122, v122, v23
    v_sub_f32 v123, v123, v23
    v_sub_f32 v124, v124, v23
    v_sub_f32 v125, v125, v23
    v_sub_f32 v126, v126, v23
    v_sub_f32 v127, v127, v23
    v_exp_f32 v112, v112
    v_exp_f32 v113, v113
    v_exp_f32 v114, v114
    v_exp_f32 v115, v115
    v_exp_f32 v116, v116
    v_exp_f32 v117, v117
    v_exp_f32 v118, v118
    v_exp_f32 v119, v119
    v_cvt_pk_bf16_f32 v160, v112, v113
    v_cvt_pk_bf16_f32 v161, v114, v115
    v_exp_f32 v120, v120
    v_exp_f32 v121, v121
    v_exp_f32 v122, v122
    v_exp_f32 v123, v123
    v_cvt_pk_bf16_f32 v162, v116, v117
    v_cvt_pk_bf16_f32 v163, v118, v119
    v_exp_f32 v124, v124
    v_exp_f32 v125, v125
    v_exp_f32 v126, v126
    v_exp_f32 v127, v127
    v_cvt_pk_bf16_f32 v164, v120, v121
    v_cvt_pk_bf16_f32 v165, v122, v123
    v_cvt_pk_bf16_f32 v166, v124, v125
    v_cvt_pk_bf16_f32 v167, v126, v127
    v_mfma_f32_32x32x16_bf16 v[80:95], a[192:195], v[160:163], v[80:95]
    s_nop 0
    v_mfma_f32_32x32x16_bf16 v[80:95], a[196:199], v[164:167], v[80:95]
    v_sub_f32 v128, v128, v24
    v_sub_f32 v129, v129, v24
    v_sub_f32 v130, v130, v24
    v_sub_f32 v131, v131, v24
    v_sub_f32 v132, v132, v24
    v_sub_f32 v133, v133, v24
    v_sub_f32 v134, v134, v24
    v_sub_f32 v135, v135, v24
    v_sub_f32 v136, v136, v24
    v_sub_f32 v137, v137, v24
    v_sub_f32 v138, v138, v24
    v_sub_f32 v139, v139, v24
    v_sub_f32 v140, v140, v24
    v_sub_f32 v141, v141, v24
    v_sub_f32 v142, v142, v24
    v_sub_f32 v143, v143, v24
    v_exp_f32 v128, v128
    v_exp_f32 v129, v129
    v_exp_f32 v130, v130
    v_exp_f32 v131, v131
    v_exp_f32 v132, v132
    v_exp_f32 v133, v133
    v_exp_f32 v134, v134
    v_exp_f32 v135, v135
    v_cvt_pk_bf16_f32 v168, v128, v129
    v_cvt_pk_bf16_f32 v169, v130, v131
    v_exp_f32 v136, v136
    v_exp_f32 v137, v137
    v_exp_f32 v138, v138
    v_exp_f32 v139, v139
    v_cvt_pk_bf16_f32 v170, v132, v133
    v_cvt_pk_bf16_f32 v171, v134, v135
    v_exp_f32 v140, v140
    v_exp_f32 v141, v141
    v_exp_f32 v142, v142
    v_exp_f32 v143, v143
    v_cvt_pk_bf16_f32 v172, v136, v137
    v_cvt_pk_bf16_f32 v173, v138, v139
    v_cvt_pk_bf16_f32 v174, v140, v141
    v_cvt_pk_bf16_f32 v175, v142, v143
    v_mfma_f32_32x32x16_bf16 v[96:111], a[192:195], v[168:171], v[96:111]
    s_nop 0
    v_mfma_f32_32x32x16_bf16 v[96:111], a[196:199], v[172:175], v[96:111]
    v_mfma_f32_32x32x16_bf16 v[112:127], a[136:139], v[56:59], 0
    v_mfma_f32_32x32x16_bf16 v[128:143], a[136:139], v[60:63], 0
    s_nop 10
    v_sub_f32 v112, v112, v23
    v_sub_f32 v113, v113, v23
    v_sub_f32 v114, v114, v23
    v_sub_f32 v115, v115, v23
    v_sub_f32 v116, v116, v23
    v_sub_f32 v117, v117, v23
    v_sub_f32 v118, v118, v23
    v_sub_f32 v119, v119, v23
    v_sub_f32 v120, v120, v23
    v_sub_f32 v121, v121, v23
    v_sub_f32 v122, v122, v23
    v_sub_f32 v123, v123, v23
    v_sub_f32 v124, v124, v23
    v_sub_f32 v125, v125, v23
    v_sub_f32 v126, v126, v23
    v_sub_f32 v127, v127, v23
    v_exp_f32 v112, v112
    v_exp_f32 v113, v113
    v_exp_f32 v114, v114
    v_exp_f32 v115, v115
    v_exp_f32 v116, v116
    v_exp_f32 v117, v117
    v_exp_f32 v118, v118
    v_exp_f32 v119, v119
    v_cvt_pk_bf16_f32 v160, v112, v113
    v_cvt_pk_bf16_f32 v161, v114, v115
    v_exp_f32 v120, v120
    v_exp_f32 v121, v121
    v_exp_f32 v122, v122
    v_exp_f32 v123, v123
    v_cvt_pk_bf16_f32 v162, v116, v117
    v_cvt_pk_bf16_f32 v163, v118, v119
    v_exp_f32 v124, v124
    v_exp_f32 v125, v125
    v_exp_f32 v126, v126
    v_exp_f32 v127, v127
    v_cvt_pk_bf16_f32 v164, v120, v121
    v_cvt_pk_bf16_f32 v165, v122, v123
    v_cvt_pk_bf16_f32 v166, v124, v125
    v_cvt_pk_bf16_f32 v167, v126, v127
    v_mfma_f32_32x32x16_bf16 v[80:95], a[184:187], v[160:163], v[80:95]
    s_nop 0
    v_mfma_f32_32x32x16_bf16 v[80:95], a[188:191], v[164:167], v[80:95]
    v_sub_f32 v128, v128, v24
    v_sub_f32 v129, v129, v24
    v_sub_f32 v130, v130, v24
    v_sub_f32 v131, v131, v24
    v_sub_f32 v132, v132, v24
    v_sub_f32 v133, v133, v24
    v_sub_f32 v134, v134, v24
    v_sub_f32 v135, v135, v24
    v_sub_f32 v136, v136, v24
    v_sub_f32 v137, v137, v24
    v_sub_f32 v138, v138, v24
    v_sub_f32 v139, v139, v24
    v_sub_f32 v140, v140, v24
    v_sub_f32 v141, v141, v24
    v_sub_f32 v142, v142, v24
    v_sub_f32 v143, v143, v24
    v_exp_f32 v128, v128
    v_exp_f32 v129, v129
    v_exp_f32 v130, v130
    v_exp_f32 v131, v131
    v_exp_f32 v132, v132
    v_exp_f32 v133, v133
    v_exp_f32 v134, v134
    v_exp_f32 v135, v135
    v_cvt_pk_bf16_f32 v168, v128, v129
    v_cvt_pk_bf16_f32 v169, v130, v131
    v_exp_f32 v136, v136
    v_exp_f32 v137, v137
    v_exp_f32 v138, v138
    v_exp_f32 v139, v139
    v_cvt_pk_bf16_f32 v170, v132, v133
    v_cvt_pk_bf16_f32 v171, v134, v135
    v_exp_f32 v140, v140
    v_exp_f32 v141, v141
    v_exp_f32 v142, v142
    v_exp_f32 v143, v143
    v_cvt_pk_bf16_f32 v172, v136, v137
    v_cvt_pk_bf16_f32 v173, v138, v139
    v_cvt_pk_bf16_f32 v174, v140, v141
    v_cvt_pk_bf16_f32 v175, v142, v143
    v_mfma_f32_32x32x16_bf16 v[96:111], a[184:187], v[168:171], v[96:111]
    s_nop 0
    v_mfma_f32_32x32x16_bf16 v[96:111], a[188:191], v[172:175], v[96:111]
    s_nop 11
    s_cmp_eq_u32 s58, 6
    s_cbranch_scc1 L_sdone_19
    v_mfma_f32_32x32x16_bf16 v[112:127], a[132:135], v[56:59], 0
    v_mfma_f32_32x32x16_bf16 v[128:143], a[132:135], v[60:63], 0
    s_nop 10
    v_sub_f32 v112, v112, v23
    v_sub_f32 v113, v113, v23
    v_sub_f32 v114, v114, v23
    v_sub_f32 v115, v115, v23
    v_sub_f32 v116, v116, v23
    v_sub_f32 v117, v117, v23
    v_sub_f32 v118, v118, v23
    v_sub_f32 v119, v119, v23
    v_sub_f32 v120, v120, v23
    v_sub_f32 v121, v121, v23
    v_sub_f32 v122, v122, v23
    v_sub_f32 v123, v123, v23
    v_sub_f32 v124, v124, v23
    v_sub_f32 v125, v125, v23
    v_sub_f32 v126, v126, v23
    v_sub_f32 v127, v127, v23
    v_exp_f32 v112, v112
    v_exp_f32 v113, v113
    v_exp_f32 v114, v114
    v_exp_f32 v115, v115
    v_exp_f32 v116, v116
    v_exp_f32 v117, v117
    v_exp_f32 v118, v118
    v_exp_f32 v119, v119
    v_cvt_pk_bf16_f32 v160, v112, v113
    v_cvt_pk_bf16_f32 v161, v114, v115
    v_exp_f32 v120, v120
    v_exp_f32 v121, v121
    v_exp_f32 v122, v122
    v_exp_f32 v123, v123
    v_cvt_pk_bf16_f32 v162, v116, v117
    v_cvt_pk_bf16_f32 v163, v118, v119
    v_exp_f32 v124, v124
    v_exp_f32 v125, v125
    v_exp_f32 v126, v126
    v_exp_f32 v127, v127
    v_cvt_pk_bf16_f32 v164, v120, v121
    v_cvt_pk_bf16_f32 v165, v122, v123
    v_cvt_pk_bf16_f32 v166, v124, v125
    v_cvt_pk_bf16_f32 v167, v126, v127
    v_mfma_f32_32x32x16_bf16 v[80:95], a[176:179], v[160:163], v[80:95]
    s_nop 0
    v_mfma_f32_32x32x16_bf16 v[80:95], a[180:183], v[164:167], v[80:95]
    v_sub_f32 v128, v128, v24
    v_sub_f32 v129, v129, v24
    v_sub_f32 v130, v130, v24
    v_sub_f32 v131, v131, v24
    v_sub_f32 v132, v132, v24
    v_sub_f32 v133, v133, v24
    v_sub_f32 v134, v134, v24
    v_sub_f32 v135, v135, v24
    v_sub_f32 v136, v136, v24
    v_sub_f32 v137, v137, v24
    v_sub_f32 v138, v138, v24
    v_sub_f32 v139, v139, v24
    v_sub_f32 v140, v140, v24
    v_sub_f32 v141, v141, v24
    v_sub_f32 v142, v142, v24
    v_sub_f32 v143, v143, v24
    v_cndmask_b32 v128, v128, v25, s[64:65]
    v_cndmask_b32 v129, v129, v25, s[66:67]
    v_cndmask_b32 v130, v130, v25, s[68:69]
    v_cndmask_b32 v131, v131, v25, s[70:71]
    v_cndmask_b32 v132, v132, v25, s[72:73]
    v_cndmask_b32 v133, v133, v25, s[74:75]
    v_cndmask_b32 v134, v134, v25, s[76:77]
    v_cndmask_b32 v135, v135, v25, s[78:79]
    v_cndmask_b32 v136, v136, v25, s[80:81]
    v_cndmask_b32 v137, v137, v25, s[82:83]
    v_cndmask_b32 v138, v138, v25, s[84:85]
    v_cndmask_b32 v139, v139, v25, s[86:87]
    v_cndmask_b32 v140, v140, v25, s[88:89]
    v_cndmask_b32 v141, v141, v25, s[90:91]
    v_cndmask_b32 v142, v142, v25, s[92:93]
    v_cndmask_b32 v143, v143, v25, s[94:95]
    v_exp_f32 v128, v128
    v_exp_f32 v129, v129
    v_exp_f32 v130, v130
    v_exp_f32 v131, v131
    v_exp_f32 v132, v132
    v_exp_f32 v133, v133
    v_exp_f32 v134, v134
    v_exp_f32 v135, v135
    v_cvt_pk_bf16_f32 v168, v128, v129
    v_cvt_pk_bf16_f32 v169, v130, v131
    v_exp_f32 v136, v136
    v_exp_f32 v137, v137
    v_exp_f32 v138, v138
    v_exp_f32 v139, v139
    v_cvt_pk_bf16_f32 v170, v132, v133
    v_cvt_pk_bf16_f32 v171, v134, v135
    v_exp_f32 v140, v140
    v_exp_f32 v141, v141
    v_exp_f32 v142, v142
    v_exp_f32 v143, v143
    v_cvt_pk_bf16_f32 v172, v136, v137
    v_cvt_pk_bf16_f32 v173, v138, v139
    v_cvt_pk_bf16_f32 v174, v140, v141
    v_cvt_pk_bf16_f32 v175, v142, v143
    v_mfma_f32_32x32x16_bf16 v[96:111], a[176:179], v[168:171], v[96:111]
    s_nop 0
    v_mfma_f32_32x32x16_bf16 v[96:111], a[180:183], v[172:175], v[96:111]
    v_mfma_f32_32x32x16_bf16 v[112:127], a[128:131], v[56:59], 0
    s_nop 11
    v_sub_f32 v112, v112, v23
    v_sub_f32 v113, v113, v23
    v_sub_f32 v114, v114, v23
    v_sub_f32 v115, v115, v23
    v_sub_f32 v116, v116, v23
    v_sub_f32 v117, v117, v23
    v_sub_f32 v118, v118, v23
    v_sub_f32 v119, v119, v23
    v_sub_f32 v120, v120, v23
    v_sub_f32 v121, v121, v23
    v_sub_f32 v122, v122, v23
    v_sub_f32 v123, v123, v23
    v_sub_f32 v124, v124, v23
    v_sub_f32 v125, v125, v23
    v_sub_f32 v126, v126, v23
    v_sub_f32 v127, v127, v23
    v_cndmask_b32 v112, v112, v25, s[64:65]
    v_cndmask_b32 v113, v113, v25, s[66:67]
    v_cndmask_b32 v114, v114, v25, s[68:69]
    v_cndmask_b32 v115, v115, v25, s[70:71]
    v_cndmask_b32 v116, v116, v25, s[72:73]
    v_cndmask_b32 v117, v117, v25, s[74:75]
    v_cndmask_b32 v118, v118, v25, s[76:77]
    v_cndmask_b32 v119, v119, v25, s[78:79]
    v_cndmask_b32 v120, v120, v25, s[80:81]
    v_cndmask_b32 v121, v121, v25, s[82:83]
    v_cndmask_b32 v122, v122, v25, s[84:85]
    v_cndmask_b32 v123, v123, v25, s[86:87]
    v_cndmask_b32 v124, v124, v25, s[88:89]
    v_cndmask_b32 v125, v125, v25, s[90:91]
    v_cndmask_b32 v126, v126, v25, s[92:93]
    v_cndmask_b32 v127, v127, v25, s[94:95]
    v_exp_f32 v112, v112
    v_exp_f32 v113, v113
    v_exp_f32 v114, v114
    v_exp_f32 v115, v115
    v_exp_f32 v116, v116
    v_exp_f32 v117, v117
    v_exp_f32 v118, v118
    v_exp_f32 v119, v119
    v_cvt_pk_bf16_f32 v160, v112, v113
    v_cvt_pk_bf16_f32 v161, v114, v115
    v_exp_f32 v120, v120
    v_exp_f32 v121, v121
    v_exp_f32 v122, v122
    v_exp_f32 v123, v123
    v_cvt_pk_bf16_f32 v162, v116, v117
    v_cvt_pk_bf16_f32 v163, v118, v119
    v_exp_f32 v124, v124
    v_exp_f32 v125, v125
    v_exp_f32 v126, v126
    v_exp_f32 v127, v127
    v_cvt_pk_bf16_f32 v164, v120, v121
    v_cvt_pk_bf16_f32 v165, v122, v123
    v_cvt_pk_bf16_f32 v166, v124, v125
    v_cvt_pk_bf16_f32 v167, v126, v127
    v_mfma_f32_32x32x16_bf16 v[80:95], a[168:171], v[160:163], v[80:95]
    s_nop 0
    v_mfma_f32_32x32x16_bf16 v[80:95], a[172:175], v[164:167], v[80:95]
    s_nop 11
L_sdone_19:
    s_branch L_attn_ok_16
L_poll_retry_20:
    s_sub_u32 s57, s57, 1
    s_cbranch_scc1 L_end
    s_mov_b32 s56, 32768
    buffer_load_dword v7, v6, s[32:35], s56 offen sc1
    s_waitcnt vmcnt(0)
    v_cmp_ne_u32 vcc, s49, v7
    s_nop 0
    s_cbranch_vccnz L_poll_retry_20
    s_branch L_poll_ok_21
L_poll_retry_22:
    s_sub_u32 s57, s57, 1
    s_cbranch_scc1 L_end
    s_mov_b32 s56, 65536
    buffer_load_dword v7, v6, s[32:35], s56 offen sc1
    s_waitcnt vmcnt(0)
    v_cmp_ne_u32 vcc, s49, v7
    s_nop 0
    s_cbranch_vccnz L_poll_retry_22
    s_branch L_poll_ok_23
L_end:
    s_endpgm
.section .rodata,"a"
.p2align 6
.amdhsa_kernel parallel_sum__sliding_block__dense_activation_squared_relu__prompt_kernel
  .amdhsa_next_free_vgpr 512
  .amdhsa_next_free_sgpr 102
  .amdhsa_accum_offset 256
  .amdhsa_group_segment_fixed_size 0
  .amdhsa_kernarg_size 88
  .amdhsa_user_sgpr_count 2
  .amdhsa_user_sgpr_kernarg_segment_ptr 1
  .amdhsa_system_sgpr_workgroup_id_x 1
  .amdhsa_float_denorm_mode_32 3
.end_amdhsa_kernel
```
